```python
import torch

def _softmax(x, axis=-1):
    return torch.softmax(x, dim=axis)
def _gelu(x):
    return torch.nn.functional.gelu(x, approximate="tanh")
def _silu(x):
    return torch.nn.functional.silu(x)
def _sigmoid(x):
    return torch.sigmoid(x)
def _layernorm(x, axis=-1, eps=1e-5):
    m = x.mean(dim=axis, keepdim=True)
    v = x.var(dim=axis, keepdim=True, unbiased=False)
    return (x - m) / torch.sqrt(v + eps)
def _scatter_add(tgt, idx, src, axis=0):
    return tgt.clone().index_add_(axis, idx, src)
def _segment_sum(src, seg, n):
    out = torch.zeros((n,) + src.shape[1:], dtype=src.dtype)
    return out.index_add_(0, seg, src)
def _pad(x, pw):
    flat = tuple(v for pair in reversed(pw) for v in pair)
    return torch.nn.functional.pad(x, flat)

kernel_name = 'parallel_sum__ssm_conv_h3__dense_activation_gelu__prompt'

def setup_inputs():

    _w = (lambda a: (lambda t: t.to(torch.bfloat16) if t.is_floating_point() else t)(torch.as_tensor(a)))
    def _A_setup():
        B, S, D = 1, 2048, 640
        ks = 4
        return {
            "q": _w((lambda *s: torch.randn(*s, dtype=torch.bfloat16) * 0.05)(B, S, D)),
            "k": _w((lambda *s: torch.randn(*s, dtype=torch.bfloat16) * 0.2)(B, S, D)),
            "v": _w((lambda *s: torch.randn(*s, dtype=torch.bfloat16) * 0.2)(B, S, D)),
            "shift_k": _w((lambda *s: torch.randn(*s, dtype=torch.bfloat16) * 0.2)(D, ks) * 0.5),
            "ssm_k": _w((lambda *s: torch.randn(*s, dtype=torch.bfloat16) * 0.8)(D, S) * (1.0 / S ** 0.5)),
            "ssm_D": _w((lambda *s: torch.randn(*s, dtype=torch.bfloat16) * 0.2)(D)),
        }
    _A_in = _A_setup()

    def _B_setup():
        B, S, D, F = 1, 2048, 640, 1536
        return {
            "x": _w((lambda *s: torch.randn(*s, dtype=torch.bfloat16) * 0.05)(B, S, D)),
            "w1": _w((lambda *s: torch.randn(*s, dtype=torch.bfloat16) * 0.4)(D, F) * (D ** -0.5)),
            "b1": _w((lambda *s: torch.randn(*s, dtype=torch.bfloat16) * 12.8)(F) * 0.01),
            "w2": _w((lambda *s: torch.randn(*s, dtype=torch.bfloat16) * 0.2)(F, D) * (F ** -0.5)),
            "b2": _w((lambda *s: torch.randn(*s, dtype=torch.bfloat16) * 3.2)(D) * 0.01),
        }
    _B_in = _B_setup()

    return {
        "A_q": _A_in["q"],
        "A_k": _A_in["k"],
        "A_v": _A_in["v"],
        "A_shift_k": _A_in["shift_k"],
        "A_ssm_k": _A_in["ssm_k"],
        "A_ssm_D": _A_in["ssm_D"],
        "B_x": _B_in["x"],
        "B_w1": _B_in["w1"],
        "B_b1": _B_in["b1"],
        "B_w2": _B_in["w2"],
        "B_b2": _B_in["b2"],
    }

def reference(A_q, A_k, A_v, A_shift_k, A_ssm_k, A_ssm_D, B_x, B_w1, B_b1, B_w2, B_b2):
    def _A_ref(q, k, v, shift_k, ssm_k, ssm_D):
        B, S, D = q.shape
        ks = shift_k.shape[-1]
        k_pad = _pad(k, ((0, 0), (ks - 1, 0), (0, 0)))
        k_shift = torch.zeros_like(k)
        for t in range(ks):
            k_shift = k_shift + k_pad[:, t:t + S, :] * shift_k[:, ks - 1 - t][None, None, :]
        kv = k_shift * v
        L = 2 * S
        kv_pad = _pad(kv, ((0, 0), (0, S), (0, 0)))
        kf_pad = _pad(ssm_k, ((0, 0), (0, S)))
        kv_f = (lambda x, axes=(-2,-1): torch.fft.rfft2(x.float(), dim=axes))(kv_pad[:, None, :, :], axes=(1, 2))
        kf_f = (lambda x, axes=(-2,-1): torch.fft.rfft2(x.float(), dim=axes))(kf_pad[:, None, :], axes=(1, 2))
        kf_f = (lambda x, *d: x.permute(*d))(kf_f, 1, 2, 0)
        y_f = kv_f * kf_f[None, :, :, :]
        y = (lambda x, s, axes=(-2,-1): torch.fft.irfft2(x, s=s, dim=axes).to(torch.bfloat16))(y_f, (1, L), axes=(1, 2))[:, 0, :S, :]
        y = y + kv * ssm_D[None, None, :]
        return q * y

    def _B_ref(x, w1, b1, w2, b2):
        h = torch.einsum("bsd,df->bsf", x, w1) + b1
        h = _gelu(h)
        return torch.einsum("bsf,fd->bsd", h, w2) + b2

    x = A_q
    xn = _layernorm(x, axis=-1)
    return x + _A_ref(xn, A_k, A_v, A_shift_k, A_ssm_k, A_ssm_D) + _B_ref(xn, B_w1, B_b1, B_w2, B_b2)
```

```asm
; @launch grid=(256,1,1) block=(512,1,1) lds=159104
.amdgcn_target "amdgcn-amd-amdhsa--gfx950"
.text
    .globl parallel_sum__ssm_conv_h3__dense_activation_gelu__prompt_kernel
    .p2align 8
    .type parallel_sum__ssm_conv_h3__dense_activation_gelu__prompt_kernel,@function
parallel_sum__ssm_conv_h3__dense_activation_gelu__prompt_kernel:
    s_cmp_ge_u32 s2, 256
    s_cbranch_scc1 A_exit
    v_lshrrev_b32 v1, 6, v0
    s_nop 0
    v_readfirstlane_b32 s24, v1
    v_and_b32 v1, 63, v0
    v_and_b32 v2, 15, v1
    v_lshrrev_b32 v3, 4, v1
    s_nop 1
    s_cmp_ge_u32 s24, 4
    s_cbranch_scc1 A_prep
    s_setprio 2
    s_load_dwordx2 s[4:5], s[0:1], 0
    s_load_dwordx2 s[6:7], s[0:1], 56
    s_load_dwordx2 s[32:33], s[0:1], 64
    s_load_dwordx2 s[34:35], s[0:1], 104
    v_lshlrev_b32 v180, 4, v1
    v_add_u32 v180, 114688, v180
    v_mov_b32 v184, 0
    v_mov_b32 v185, 0
    v_mov_b32 v186, 0
    v_mov_b32 v187, 0
    v_cmp_gt_u32 vcc, 32, v0
    s_nop 1
    s_and_saveexec_b64 s[42:43], vcc
    s_cbranch_execz A_nozero0
    ds_write_b128 v180, v[184:187]
A_nozero0:
    s_mov_b64 exec, -1
    s_and_b32 s27, s2, 7
    s_lshr_b32 s28, s2, 3
    s_lshr_b32 s25, s27, 1
    s_lshl_b32 s25, s25, 2
    s_and_b32 s29, s28, 3
    s_add_u32 s25, s25, s29
    s_and_b32 s26, s27, 1
    s_lshl_b32 s26, s26, 3
    s_lshr_b32 s29, s28, 2
    s_add_u32 s26, s26, s29
    s_mul_i32 s30, s24, 3072
    s_lshl_b32 s31, s24, 12
    s_mul_i32 s36, s24, 192
    s_mul_i32 s37, s26, 192
    s_mov_b32 s38, 43691
    v_add_u32 v180, s36, v1
    v_add_u32 v180, 0, v180
    v_mul_lo_u32 v181, v180, s38
    v_lshrrev_b32 v181, 19, v181
    v_mul_u32_u24 v182, 12, v181
    v_sub_u32 v182, v180, v182
    v_lshrrev_b32 v183, 2, v181
    v_and_b32 v183, 2, v183
    v_xor_b32 v182, v182, v183
    v_lshlrev_b32 v182, 4, v182
    v_mul_u32_u24 v181, 3072, v181
    v_add_u32 v181, v181, v182
    v_add_u32 v160, s37, v181
    v_add_u32 v180, s36, v1
    v_add_u32 v180, 64, v180
    v_mul_lo_u32 v181, v180, s38
    v_lshrrev_b32 v181, 19, v181
    v_mul_u32_u24 v182, 12, v181
    v_sub_u32 v182, v180, v182
    v_lshrrev_b32 v183, 2, v181
    v_and_b32 v183, 2, v183
    v_xor_b32 v182, v182, v183
    v_lshlrev_b32 v182, 4, v182
    v_mul_u32_u24 v181, 3072, v181
    v_add_u32 v181, v181, v182
    v_add_u32 v161, s37, v181
    v_add_u32 v180, s36, v1
    v_add_u32 v180, 128, v180
    v_mul_lo_u32 v181, v180, s38
    v_lshrrev_b32 v181, 19, v181
    v_mul_u32_u24 v182, 12, v181
    v_sub_u32 v182, v180, v182
    v_lshrrev_b32 v183, 2, v181
    v_and_b32 v183, 2, v183
    v_xor_b32 v182, v182, v183
    v_lshlrev_b32 v182, 4, v182
    v_mul_u32_u24 v181, 3072, v181
    v_add_u32 v181, v181, v182
    v_add_u32 v162, s37, v181
    s_lshl_b32 s39, s25, 7
    s_lshl_b32 s40, s24, 5
    s_add_u32 s39, s39, s40
    v_lshrrev_b32 v180, 3, v1
    v_and_b32 v181, 7, v1
    v_xor_b32 v181, v181, v180
    v_lshlrev_b32 v181, 4, v181
    v_add_u32 v180, s39, v180
    v_mul_u32_u24 v180, 1280, v180
    v_add_u32 v163, v180, v181
    v_and_b32 v180, 7, v2
    v_xor_b32 v180, v180, v3
    v_lshlrev_b32 v180, 4, v180
    v_lshlrev_b32 v181, 7, v2
    v_add_u32 v180, v180, v181
    v_add_u32 v180, s31, v180
    v_add_u32 v164, 49152, v180
    v_xor_b32 v165, 64, v164
    v_bfe_u32 v180, v1, 2, 2
    v_lshlrev_b32 v181, 3, v3
    v_add_u32 v180, v180, v181
    v_mul_u32_u24 v180, 192, v180
    v_and_b32 v181, 3, v1
    v_lshlrev_b32 v181, 3, v181
    v_add_u32 v180, v180, v181
    v_and_b32 v181, 1, v3
    v_lshlrev_b32 v181, 5, v181
    v_add_u32 v166, v180, v181
    v_sub_u32 v167, v180, v181
    s_waitcnt lgkmcnt(0)
    s_mov_b32 s8, s4
    s_mov_b32 s9, s5
    s_mov_b32 s10, 2621440
    s_mov_b32 s11, 0x00020000
    s_mov_b32 s12, s6
    s_mov_b32 s13, s7
    s_mov_b32 s14, 1966080
    s_mov_b32 s15, 0x00020000
    s_mov_b32 s16, s34
    s_mov_b32 s17, s35
    s_mov_b32 s18, 13680640
    s_mov_b32 s19, 0x00020000
    s_mov_b32 s20, s32
    s_mov_b32 s21, s33
    s_mov_b32 s22, 3072
    s_mov_b32 s23, 0x00020000
    v_lshlrev_b32 v180, 3, v3
    v_add_u32 v180, s37, v180
    buffer_load_dwordx2 v[168:169], v180, s[20:23], 0 offen offset:0
    buffer_load_dwordx2 v[170:171], v180, s[20:23], 0 offen offset:32
    buffer_load_dwordx2 v[172:173], v180, s[20:23], 0 offen offset:64
    buffer_load_dwordx2 v[174:175], v180, s[20:23], 0 offen offset:96
    buffer_load_dwordx2 v[176:177], v180, s[20:23], 0 offen offset:128
    buffer_load_dwordx2 v[178:179], v180, s[20:23], 0 offen offset:160
    s_add_u32 m0, s30, 0
    s_mov_b32 s41, 0
    buffer_load_dwordx4 v160, s[12:15], s41 offen lds
    s_add_u32 m0, s30, 1024
    s_mov_b32 s41, 0
    buffer_load_dwordx4 v161, s[12:15], s41 offen lds
    s_add_u32 m0, s30, 2048
    s_mov_b32 s41, 0
    buffer_load_dwordx4 v162, s[12:15], s41 offen lds
    s_add_u32 m0, s31, 49152
    s_mov_b32 s41, 0
    buffer_load_dwordx4 v163, s[8:11], s41 offen lds
    s_add_u32 m0, s31, 50176
    s_mov_b32 s41, 10240
    buffer_load_dwordx4 v163, s[8:11], s41 offen lds
    s_add_u32 m0, s31, 51200
    s_mov_b32 s41, 20480
    buffer_load_dwordx4 v163, s[8:11], s41 offen lds
    s_add_u32 m0, s31, 52224
    s_mov_b32 s41, 30720
    buffer_load_dwordx4 v163, s[8:11], s41 offen lds
    s_add_u32 m0, s30, 12288
    s_mov_b32 s41, 196608
    buffer_load_dwordx4 v160, s[12:15], s41 offen lds
    s_add_u32 m0, s30, 13312
    s_mov_b32 s41, 196608
    buffer_load_dwordx4 v161, s[12:15], s41 offen lds
    s_add_u32 m0, s30, 14336
    s_mov_b32 s41, 196608
    buffer_load_dwordx4 v162, s[12:15], s41 offen lds
    s_add_u32 m0, s31, 65536
    s_mov_b32 s41, 128
    buffer_load_dwordx4 v163, s[8:11], s41 offen lds
    s_add_u32 m0, s31, 66560
    s_mov_b32 s41, 10368
    buffer_load_dwordx4 v163, s[8:11], s41 offen lds
    s_add_u32 m0, s31, 67584
    s_mov_b32 s41, 20608
    buffer_load_dwordx4 v163, s[8:11], s41 offen lds
    s_add_u32 m0, s31, 68608
    s_mov_b32 s41, 30848
    buffer_load_dwordx4 v163, s[8:11], s41 offen lds
    s_add_u32 m0, s30, 24576
    s_mov_b32 s41, 393216
    buffer_load_dwordx4 v160, s[12:15], s41 offen lds
    s_add_u32 m0, s30, 25600
    s_mov_b32 s41, 393216
    buffer_load_dwordx4 v161, s[12:15], s41 offen lds
    s_add_u32 m0, s30, 26624
    s_mov_b32 s41, 393216
    buffer_load_dwordx4 v162, s[12:15], s41 offen lds
    s_add_u32 m0, s31, 81920
    s_mov_b32 s41, 256
    buffer_load_dwordx4 v163, s[8:11], s41 offen lds
    s_add_u32 m0, s31, 82944
    s_mov_b32 s41, 10496
    buffer_load_dwordx4 v163, s[8:11], s41 offen lds
    s_add_u32 m0, s31, 83968
    s_mov_b32 s41, 20736
    buffer_load_dwordx4 v163, s[8:11], s41 offen lds
    s_add_u32 m0, s31, 84992
    s_mov_b32 s41, 30976
    buffer_load_dwordx4 v163, s[8:11], s41 offen lds
    s_add_u32 m0, s30, 36864
    s_mov_b32 s41, 589824
    buffer_load_dwordx4 v160, s[12:15], s41 offen lds
    s_add_u32 m0, s30, 37888
    s_mov_b32 s41, 589824
    buffer_load_dwordx4 v161, s[12:15], s41 offen lds
    s_add_u32 m0, s30, 38912
    s_mov_b32 s41, 589824
    buffer_load_dwordx4 v162, s[12:15], s41 offen lds
    s_add_u32 m0, s31, 98304
    s_mov_b32 s41, 384
    buffer_load_dwordx4 v163, s[8:11], s41 offen lds
    s_add_u32 m0, s31, 99328
    s_mov_b32 s41, 10624
    buffer_load_dwordx4 v163, s[8:11], s41 offen lds
    s_add_u32 m0, s31, 100352
    s_mov_b32 s41, 20864
    buffer_load_dwordx4 v163, s[8:11], s41 offen lds
    s_add_u32 m0, s31, 101376
    s_mov_b32 s41, 31104
    buffer_load_dwordx4 v163, s[8:11], s41 offen lds
    v_mov_b32 v16, 0
    v_mov_b32 v17, 0
    v_mov_b32 v18, 0
    v_mov_b32 v19, 0
    v_mov_b32 v20, 0
    v_mov_b32 v21, 0
    v_mov_b32 v22, 0
    v_mov_b32 v23, 0
    v_mov_b32 v24, 0
    v_mov_b32 v25, 0
    v_mov_b32 v26, 0
    v_mov_b32 v27, 0
    v_mov_b32 v28, 0
    v_mov_b32 v29, 0
    v_mov_b32 v30, 0
    v_mov_b32 v31, 0
    v_mov_b32 v32, 0
    v_mov_b32 v33, 0
    v_mov_b32 v34, 0
    v_mov_b32 v35, 0
    v_mov_b32 v36, 0
    v_mov_b32 v37, 0
    v_mov_b32 v38, 0
    v_mov_b32 v39, 0
    v_mov_b32 v40, 0
    v_mov_b32 v41, 0
    v_mov_b32 v42, 0
    v_mov_b32 v43, 0
    v_mov_b32 v44, 0
    v_mov_b32 v45, 0
    v_mov_b32 v46, 0
    v_mov_b32 v47, 0
    v_mov_b32 v48, 0
    v_mov_b32 v49, 0
    v_mov_b32 v50, 0
    v_mov_b32 v51, 0
    v_mov_b32 v52, 0
    v_mov_b32 v53, 0
    v_mov_b32 v54, 0
    v_mov_b32 v55, 0
    v_mov_b32 v56, 0
    v_mov_b32 v57, 0
    v_mov_b32 v58, 0
    v_mov_b32 v59, 0
    v_mov_b32 v60, 0
    v_mov_b32 v61, 0
    v_mov_b32 v62, 0
    v_mov_b32 v63, 0
    v_mov_b32 v64, 0
    v_mov_b32 v65, 0
    v_mov_b32 v66, 0
    v_mov_b32 v67, 0
    v_mov_b32 v68, 0
    v_mov_b32 v69, 0
    v_mov_b32 v70, 0
    v_mov_b32 v71, 0
    v_mov_b32 v72, 0
    v_mov_b32 v73, 0
    v_mov_b32 v74, 0
    v_mov_b32 v75, 0
    v_mov_b32 v76, 0
    v_mov_b32 v77, 0
    v_mov_b32 v78, 0
    v_mov_b32 v79, 0
    v_mov_b32 v80, 0
    v_mov_b32 v81, 0
    v_mov_b32 v82, 0
    v_mov_b32 v83, 0
    v_mov_b32 v84, 0
    v_mov_b32 v85, 0
    v_mov_b32 v86, 0
    v_mov_b32 v87, 0
    v_mov_b32 v236, 0
    v_mov_b32 v237, 0
    v_mov_b32 v238, 0
    v_mov_b32 v239, 0
    v_mov_b32 v240, 0
    v_mov_b32 v241, 0
    v_mov_b32 v242, 0
    v_mov_b32 v243, 0
    v_mov_b32 v244, 0
    v_mov_b32 v245, 0
    v_mov_b32 v246, 0
    v_mov_b32 v247, 0
    v_mov_b32 v248, 0
    v_mov_b32 v249, 0
    v_mov_b32 v250, 0
    v_mov_b32 v251, 0
    v_mov_b32 v156, 0x3f803f80
    v_mov_b32 v157, 0x3f803f80
    v_mov_b32 v158, 0x3f803f80
    v_mov_b32 v159, 0x3f803f80
    v_mov_b32 v233, 115072
    s_lshl_b32 s42, s24, 2
    v_add_u32 v232, s42, v233
    s_barrier
    s_waitcnt vmcnt(21)
    v_mov_b32 v234, 1
    s_mov_b64 exec, 1
    ds_write_b32 v232, v234
    s_mov_b64 exec, -1
L_sy_1:
    ds_read_b128 v[228:231], v233
    s_waitcnt lgkmcnt(0)
    v_min3_u32 v228, v228, v229, v230
    v_min_u32 v228, v228, v231
    v_cmp_gt_u32 vcc, 1, v228
    s_nop 1
    s_cbranch_vccnz L_sy_1
    ds_read_b128 v[136:139], v164 offset:0
    ds_read_b128 v[140:143], v164 offset:2048
    ds_read_b64_tr_b16 v[88:89], v166 offset:0
    ds_read_b64_tr_b16 v[90:91], v166 offset:768
    ds_read_b64_tr_b16 v[92:93], v167 offset:32
    ds_read_b64_tr_b16 v[94:95], v167 offset:800
    ds_read_b64_tr_b16 v[96:97], v166 offset:64
    ds_read_b64_tr_b16 v[98:99], v166 offset:832
    ds_read_b64_tr_b16 v[100:101], v167 offset:96
    ds_read_b64_tr_b16 v[102:103], v167 offset:864
    ds_read_b64_tr_b16 v[104:105], v166 offset:128
    ds_read_b64_tr_b16 v[106:107], v166 offset:896
    ds_read_b64_tr_b16 v[108:109], v167 offset:160
    ds_read_b64_tr_b16 v[110:111], v167 offset:928
    s_waitcnt lgkmcnt(0)
    v_mfma_f32_16x16x32_bf16 v[236:239], v[156:159], v[136:139], v[236:239]
    v_mfma_f32_16x16x32_bf16 v[244:247], v[136:139], v[136:139], v[244:247]
    v_mfma_f32_16x16x32_bf16 v[240:243], v[156:159], v[140:143], v[240:243]
    v_mfma_f32_16x16x32_bf16 v[248:251], v[140:143], v[140:143], v[248:251]
    v_mfma_f32_16x16x32_bf16 v[16:19], v[88:91], v[136:139], v[16:19]
    ds_read_b128 v[144:147], v165 offset:0
    ds_read_b128 v[148:151], v165 offset:2048
    ds_read_b64_tr_b16 v[112:113], v166 offset:6144
    v_mfma_f32_16x16x32_bf16 v[40:43], v[88:91], v[140:143], v[40:43]
    ds_read_b64_tr_b16 v[114:115], v166 offset:6912
    ds_read_b64_tr_b16 v[116:117], v167 offset:6176
    ds_read_b64_tr_b16 v[118:119], v167 offset:6944
    v_mfma_f32_16x16x32_bf16 v[20:23], v[92:95], v[136:139], v[20:23]
    ds_read_b64_tr_b16 v[120:121], v166 offset:6208
    ds_read_b64_tr_b16 v[122:123], v166 offset:6976
    ds_read_b64_tr_b16 v[124:125], v167 offset:6240
    v_mfma_f32_16x16x32_bf16 v[44:47], v[92:95], v[140:143], v[44:47]
    ds_read_b64_tr_b16 v[126:127], v167 offset:7008
    ds_read_b64_tr_b16 v[128:129], v166 offset:6272
    ds_read_b64_tr_b16 v[130:131], v166 offset:7040
    v_mfma_f32_16x16x32_bf16 v[24:27], v[96:99], v[136:139], v[24:27]
    ds_read_b64_tr_b16 v[132:133], v167 offset:6304
    ds_read_b64_tr_b16 v[134:135], v167 offset:7072
    v_mfma_f32_16x16x32_bf16 v[48:51], v[96:99], v[140:143], v[48:51]
    v_mfma_f32_16x16x32_bf16 v[28:31], v[100:103], v[136:139], v[28:31]
    v_mfma_f32_16x16x32_bf16 v[52:55], v[100:103], v[140:143], v[52:55]
    v_mfma_f32_16x16x32_bf16 v[32:35], v[104:107], v[136:139], v[32:35]
    v_mfma_f32_16x16x32_bf16 v[56:59], v[104:107], v[140:143], v[56:59]
    v_mfma_f32_16x16x32_bf16 v[36:39], v[108:111], v[136:139], v[36:39]
    v_mfma_f32_16x16x32_bf16 v[60:63], v[108:111], v[140:143], v[60:63]
    s_cmp_lg_u32 s24, 0
    s_cbranch_scc1 L_cs_3
    v_mfma_f32_16x16x32_bf16 v[64:67], v[88:91], v[156:159], v[64:67]
    v_mfma_f32_16x16x32_bf16 v[68:71], v[92:95], v[156:159], v[68:71]
    v_mfma_f32_16x16x32_bf16 v[72:75], v[96:99], v[156:159], v[72:75]
    v_mfma_f32_16x16x32_bf16 v[76:79], v[100:103], v[156:159], v[76:79]
    v_mfma_f32_16x16x32_bf16 v[80:83], v[104:107], v[156:159], v[80:83]
    v_mfma_f32_16x16x32_bf16 v[84:87], v[108:111], v[156:159], v[84:87]
L_cs_3:
    s_waitcnt lgkmcnt(0)
    s_waitcnt vmcnt(14)
    v_mov_b32 v234, 2
    s_mov_b64 exec, 1
    ds_write_b32 v232, v234
    s_mov_b64 exec, -1
    v_mfma_f32_16x16x32_bf16 v[236:239], v[156:159], v[144:147], v[236:239]
    v_mfma_f32_16x16x32_bf16 v[244:247], v[144:147], v[144:147], v[244:247]
    v_mfma_f32_16x16x32_bf16 v[240:243], v[156:159], v[148:151], v[240:243]
    ds_read_b128 v[228:231], v233
    v_mfma_f32_16x16x32_bf16 v[248:251], v[148:151], v[148:151], v[248:251]
    s_waitcnt lgkmcnt(0)
    v_min3_u32 v228, v228, v229, v230
    v_min_u32 v228, v228, v231
    v_cmp_gt_u32 vcc, 2, v228
    s_nop 1
    s_cbranch_vccz L_sd_5
L_sy_4:
    ds_read_b128 v[228:231], v233
    s_waitcnt lgkmcnt(0)
    v_min3_u32 v228, v228, v229, v230
    v_min_u32 v228, v228, v231
    v_cmp_gt_u32 vcc, 2, v228
    s_nop 1
    s_cbranch_vccnz L_sy_4
L_sd_5:
    v_mfma_f32_16x16x32_bf16 v[16:19], v[112:115], v[144:147], v[16:19]
    ds_read_b128 v[136:139], v164 offset:16384
    ds_read_b128 v[140:143], v164 offset:18432
    ds_read_b64_tr_b16 v[88:89], v166 offset:12288
    v_mfma_f32_16x16x32_bf16 v[40:43], v[112:115], v[148:151], v[40:43]
    ds_read_b64_tr_b16 v[90:91], v166 offset:13056
    ds_read_b64_tr_b16 v[92:93], v167 offset:12320
    ds_read_b64_tr_b16 v[94:95], v167 offset:13088
    v_mfma_f32_16x16x32_bf16 v[20:23], v[116:119], v[144:147], v[20:23]
    ds_read_b64_tr_b16 v[96:97], v166 offset:12352
    ds_read_b64_tr_b16 v[98:99], v166 offset:13120
    ds_read_b64_tr_b16 v[100:101], v167 offset:12384
    v_mfma_f32_16x16x32_bf16 v[44:47], v[116:119], v[148:151], v[44:47]
    ds_read_b64_tr_b16 v[102:103], v167 offset:13152
    ds_read_b64_tr_b16 v[104:105], v166 offset:12416
    ds_read_b64_tr_b16 v[106:107], v166 offset:13184
    v_mfma_f32_16x16x32_bf16 v[24:27], v[120:123], v[144:147], v[24:27]
    ds_read_b64_tr_b16 v[108:109], v167 offset:12448
    ds_read_b64_tr_b16 v[110:111], v167 offset:13216
    s_add_u32 m0, s30, 0
    s_mov_b32 s41, 786432
    buffer_load_dwordx4 v160, s[12:15], s41 offen lds
    v_mfma_f32_16x16x32_bf16 v[48:51], v[120:123], v[148:151], v[48:51]
    s_add_u32 m0, s30, 1024
    s_mov_b32 s41, 786432
    buffer_load_dwordx4 v161, s[12:15], s41 offen lds
    v_mfma_f32_16x16x32_bf16 v[28:31], v[124:127], v[144:147], v[28:31]
    s_add_u32 m0, s30, 2048
    s_mov_b32 s41, 786432
    buffer_load_dwordx4 v162, s[12:15], s41 offen lds
    v_mfma_f32_16x16x32_bf16 v[52:55], v[124:127], v[148:151], v[52:55]
    s_add_u32 m0, s31, 49152
    s_mov_b32 s41, 512
    buffer_load_dwordx4 v163, s[8:11], s41 offen lds
    v_mfma_f32_16x16x32_bf16 v[32:35], v[128:131], v[144:147], v[32:35]
    s_add_u32 m0, s31, 50176
    s_mov_b32 s41, 10752
    buffer_load_dwordx4 v163, s[8:11], s41 offen lds
    v_mfma_f32_16x16x32_bf16 v[56:59], v[128:131], v[148:151], v[56:59]
    s_add_u32 m0, s31, 51200
    s_mov_b32 s41, 20992
    buffer_load_dwordx4 v163, s[8:11], s41 offen lds
    v_mfma_f32_16x16x32_bf16 v[36:39], v[132:135], v[144:147], v[36:39]
    s_add_u32 m0, s31, 52224
    s_mov_b32 s41, 31232
    buffer_load_dwordx4 v163, s[8:11], s41 offen lds
    v_mfma_f32_16x16x32_bf16 v[60:63], v[132:135], v[148:151], v[60:63]
    s_cmp_lg_u32 s24, 1
    s_cbranch_scc1 L_cs_6
    v_mfma_f32_16x16x32_bf16 v[64:67], v[112:115], v[156:159], v[64:67]
    v_mfma_f32_16x16x32_bf16 v[68:71], v[116:119], v[156:159], v[68:71]
    v_mfma_f32_16x16x32_bf16 v[72:75], v[120:123], v[156:159], v[72:75]
    v_mfma_f32_16x16x32_bf16 v[76:79], v[124:127], v[156:159], v[76:79]
    v_mfma_f32_16x16x32_bf16 v[80:83], v[128:131], v[156:159], v[80:83]
    v_mfma_f32_16x16x32_bf16 v[84:87], v[132:135], v[156:159], v[84:87]
L_cs_6:
    s_waitcnt lgkmcnt(0)
    v_mfma_f32_16x16x32_bf16 v[236:239], v[156:159], v[136:139], v[236:239]
    v_mfma_f32_16x16x32_bf16 v[244:247], v[136:139], v[136:139], v[244:247]
    v_mfma_f32_16x16x32_bf16 v[240:243], v[156:159], v[140:143], v[240:243]
    v_mfma_f32_16x16x32_bf16 v[248:251], v[140:143], v[140:143], v[248:251]
    v_mfma_f32_16x16x32_bf16 v[16:19], v[88:91], v[136:139], v[16:19]
    ds_read_b128 v[144:147], v165 offset:16384
    ds_read_b128 v[148:151], v165 offset:18432
    ds_read_b64_tr_b16 v[112:113], v166 offset:18432
    v_mfma_f32_16x16x32_bf16 v[40:43], v[88:91], v[140:143], v[40:43]
    ds_read_b64_tr_b16 v[114:115], v166 offset:19200
    ds_read_b64_tr_b16 v[116:117], v167 offset:18464
    ds_read_b64_tr_b16 v[118:119], v167 offset:19232
    v_mfma_f32_16x16x32_bf16 v[20:23], v[92:95], v[136:139], v[20:23]
    ds_read_b64_tr_b16 v[120:121], v166 offset:18496
    ds_read_b64_tr_b16 v[122:123], v166 offset:19264
    ds_read_b64_tr_b16 v[124:125], v167 offset:18528
    v_mfma_f32_16x16x32_bf16 v[44:47], v[92:95], v[140:143], v[44:47]
    ds_read_b64_tr_b16 v[126:127], v167 offset:19296
    ds_read_b64_tr_b16 v[128:129], v166 offset:18560
    ds_read_b64_tr_b16 v[130:131], v166 offset:19328
    v_mfma_f32_16x16x32_bf16 v[24:27], v[96:99], v[136:139], v[24:27]
    ds_read_b64_tr_b16 v[132:133], v167 offset:18592
    ds_read_b64_tr_b16 v[134:135], v167 offset:19360
    v_mfma_f32_16x16x32_bf16 v[48:51], v[96:99], v[140:143], v[48:51]
    v_mfma_f32_16x16x32_bf16 v[28:31], v[100:103], v[136:139], v[28:31]
    v_mfma_f32_16x16x32_bf16 v[52:55], v[100:103], v[140:143], v[52:55]
    v_mfma_f32_16x16x32_bf16 v[32:35], v[104:107], v[136:139], v[32:35]
    v_mfma_f32_16x16x32_bf16 v[56:59], v[104:107], v[140:143], v[56:59]
    v_mfma_f32_16x16x32_bf16 v[36:39], v[108:111], v[136:139], v[36:39]
    v_mfma_f32_16x16x32_bf16 v[60:63], v[108:111], v[140:143], v[60:63]
    s_cmp_lg_u32 s24, 2
    s_cbranch_scc1 L_cs_7
    v_mfma_f32_16x16x32_bf16 v[64:67], v[88:91], v[156:159], v[64:67]
    v_mfma_f32_16x16x32_bf16 v[68:71], v[92:95], v[156:159], v[68:71]
    v_mfma_f32_16x16x32_bf16 v[72:75], v[96:99], v[156:159], v[72:75]
    v_mfma_f32_16x16x32_bf16 v[76:79], v[100:103], v[156:159], v[76:79]
    v_mfma_f32_16x16x32_bf16 v[80:83], v[104:107], v[156:159], v[80:83]
    v_mfma_f32_16x16x32_bf16 v[84:87], v[108:111], v[156:159], v[84:87]
L_cs_7:
    s_waitcnt lgkmcnt(0)
    s_waitcnt vmcnt(14)
    v_mov_b32 v234, 3
    s_mov_b64 exec, 1
    ds_write_b32 v232, v234
    s_mov_b64 exec, -1
    v_mfma_f32_16x16x32_bf16 v[236:239], v[156:159], v[144:147], v[236:239]
    v_mfma_f32_16x16x32_bf16 v[244:247], v[144:147], v[144:147], v[244:247]
    v_mfma_f32_16x16x32_bf16 v[240:243], v[156:159], v[148:151], v[240:243]
    ds_read_b128 v[228:231], v233
    v_mfma_f32_16x16x32_bf16 v[248:251], v[148:151], v[148:151], v[248:251]
    s_waitcnt lgkmcnt(0)
    v_min3_u32 v228, v228, v229, v230
    v_min_u32 v228, v228, v231
    v_cmp_gt_u32 vcc, 3, v228
    s_nop 1
    s_cbranch_vccz L_sd_9
L_sy_8:
    ds_read_b128 v[228:231], v233
    s_waitcnt lgkmcnt(0)
    v_min3_u32 v228, v228, v229, v230
    v_min_u32 v228, v228, v231
    v_cmp_gt_u32 vcc, 3, v228
    s_nop 1
    s_cbranch_vccnz L_sy_8
L_sd_9:
    v_mfma_f32_16x16x32_bf16 v[16:19], v[112:115], v[144:147], v[16:19]
    ds_read_b128 v[136:139], v164 offset:32768
    ds_read_b128 v[140:143], v164 offset:34816
    ds_read_b64_tr_b16 v[88:89], v166 offset:24576
    v_mfma_f32_16x16x32_bf16 v[40:43], v[112:115], v[148:151], v[40:43]
    ds_read_b64_tr_b16 v[90:91], v166 offset:25344
    ds_read_b64_tr_b16 v[92:93], v167 offset:24608
    ds_read_b64_tr_b16 v[94:95], v167 offset:25376
    v_mfma_f32_16x16x32_bf16 v[20:23], v[116:119], v[144:147], v[20:23]
    ds_read_b64_tr_b16 v[96:97], v166 offset:24640
    ds_read_b64_tr_b16 v[98:99], v166 offset:25408
    ds_read_b64_tr_b16 v[100:101], v167 offset:24672
    v_mfma_f32_16x16x32_bf16 v[44:47], v[116:119], v[148:151], v[44:47]
    ds_read_b64_tr_b16 v[102:103], v167 offset:25440
    ds_read_b64_tr_b16 v[104:105], v166 offset:24704
    ds_read_b64_tr_b16 v[106:107], v166 offset:25472
    v_mfma_f32_16x16x32_bf16 v[24:27], v[120:123], v[144:147], v[24:27]
    ds_read_b64_tr_b16 v[108:109], v167 offset:24736
    ds_read_b64_tr_b16 v[110:111], v167 offset:25504
    s_add_u32 m0, s30, 12288
    s_mov_b32 s41, 983040
    buffer_load_dwordx4 v160, s[12:15], s41 offen lds
    v_mfma_f32_16x16x32_bf16 v[48:51], v[120:123], v[148:151], v[48:51]
    s_add_u32 m0, s30, 13312
    s_mov_b32 s41, 983040
    buffer_load_dwordx4 v161, s[12:15], s41 offen lds
    v_mfma_f32_16x16x32_bf16 v[28:31], v[124:127], v[144:147], v[28:31]
    s_add_u32 m0, s30, 14336
    s_mov_b32 s41, 983040
    buffer_load_dwordx4 v162, s[12:15], s41 offen lds
    v_mfma_f32_16x16x32_bf16 v[52:55], v[124:127], v[148:151], v[52:55]
    s_add_u32 m0, s31, 65536
    s_mov_b32 s41, 640
    buffer_load_dwordx4 v163, s[8:11], s41 offen lds
    v_mfma_f32_16x16x32_bf16 v[32:35], v[128:131], v[144:147], v[32:35]
    s_add_u32 m0, s31, 66560
    s_mov_b32 s41, 10880
    buffer_load_dwordx4 v163, s[8:11], s41 offen lds
    v_mfma_f32_16x16x32_bf16 v[56:59], v[128:131], v[148:151], v[56:59]
    s_add_u32 m0, s31, 67584
    s_mov_b32 s41, 21120
    buffer_load_dwordx4 v163, s[8:11], s41 offen lds
    v_mfma_f32_16x16x32_bf16 v[36:39], v[132:135], v[144:147], v[36:39]
    s_add_u32 m0, s31, 68608
    s_mov_b32 s41, 31360
    buffer_load_dwordx4 v163, s[8:11], s41 offen lds
    v_mfma_f32_16x16x32_bf16 v[60:63], v[132:135], v[148:151], v[60:63]
    s_cmp_lg_u32 s24, 3
    s_cbranch_scc1 L_cs_10
    v_mfma_f32_16x16x32_bf16 v[64:67], v[112:115], v[156:159], v[64:67]
    v_mfma_f32_16x16x32_bf16 v[68:71], v[116:119], v[156:159], v[68:71]
    v_mfma_f32_16x16x32_bf16 v[72:75], v[120:123], v[156:159], v[72:75]
    v_mfma_f32_16x16x32_bf16 v[76:79], v[124:127], v[156:159], v[76:79]
    v_mfma_f32_16x16x32_bf16 v[80:83], v[128:131], v[156:159], v[80:83]
    v_mfma_f32_16x16x32_bf16 v[84:87], v[132:135], v[156:159], v[84:87]
L_cs_10:
    s_waitcnt lgkmcnt(0)
    v_mfma_f32_16x16x32_bf16 v[236:239], v[156:159], v[136:139], v[236:239]
    v_mfma_f32_16x16x32_bf16 v[244:247], v[136:139], v[136:139], v[244:247]
    v_mfma_f32_16x16x32_bf16 v[240:243], v[156:159], v[140:143], v[240:243]
    v_mfma_f32_16x16x32_bf16 v[248:251], v[140:143], v[140:143], v[248:251]
    v_mfma_f32_16x16x32_bf16 v[16:19], v[88:91], v[136:139], v[16:19]
    ds_read_b128 v[144:147], v165 offset:32768
    ds_read_b128 v[148:151], v165 offset:34816
    ds_read_b64_tr_b16 v[112:113], v166 offset:30720
    v_mfma_f32_16x16x32_bf16 v[40:43], v[88:91], v[140:143], v[40:43]
    ds_read_b64_tr_b16 v[114:115], v166 offset:31488
    ds_read_b64_tr_b16 v[116:117], v167 offset:30752
    ds_read_b64_tr_b16 v[118:119], v167 offset:31520
    v_mfma_f32_16x16x32_bf16 v[20:23], v[92:95], v[136:139], v[20:23]
    ds_read_b64_tr_b16 v[120:121], v166 offset:30784
    ds_read_b64_tr_b16 v[122:123], v166 offset:31552
    ds_read_b64_tr_b16 v[124:125], v167 offset:30816
    v_mfma_f32_16x16x32_bf16 v[44:47], v[92:95], v[140:143], v[44:47]
    ds_read_b64_tr_b16 v[126:127], v167 offset:31584
    ds_read_b64_tr_b16 v[128:129], v166 offset:30848
    ds_read_b64_tr_b16 v[130:131], v166 offset:31616
    v_mfma_f32_16x16x32_bf16 v[24:27], v[96:99], v[136:139], v[24:27]
    ds_read_b64_tr_b16 v[132:133], v167 offset:30880
    ds_read_b64_tr_b16 v[134:135], v167 offset:31648
    v_mfma_f32_16x16x32_bf16 v[48:51], v[96:99], v[140:143], v[48:51]
    v_mfma_f32_16x16x32_bf16 v[28:31], v[100:103], v[136:139], v[28:31]
    v_mfma_f32_16x16x32_bf16 v[52:55], v[100:103], v[140:143], v[52:55]
    v_mfma_f32_16x16x32_bf16 v[32:35], v[104:107], v[136:139], v[32:35]
    v_mfma_f32_16x16x32_bf16 v[56:59], v[104:107], v[140:143], v[56:59]
    v_mfma_f32_16x16x32_bf16 v[36:39], v[108:111], v[136:139], v[36:39]
    v_mfma_f32_16x16x32_bf16 v[60:63], v[108:111], v[140:143], v[60:63]
    s_cmp_lg_u32 s24, 0
    s_cbranch_scc1 L_cs_11
    v_mfma_f32_16x16x32_bf16 v[64:67], v[88:91], v[156:159], v[64:67]
    v_mfma_f32_16x16x32_bf16 v[68:71], v[92:95], v[156:159], v[68:71]
    v_mfma_f32_16x16x32_bf16 v[72:75], v[96:99], v[156:159], v[72:75]
    v_mfma_f32_16x16x32_bf16 v[76:79], v[100:103], v[156:159], v[76:79]
    v_mfma_f32_16x16x32_bf16 v[80:83], v[104:107], v[156:159], v[80:83]
    v_mfma_f32_16x16x32_bf16 v[84:87], v[108:111], v[156:159], v[84:87]
L_cs_11:
    s_waitcnt lgkmcnt(0)
    s_waitcnt vmcnt(14)
    v_mov_b32 v234, 4
    s_mov_b64 exec, 1
    ds_write_b32 v232, v234
    s_mov_b64 exec, -1
    v_mfma_f32_16x16x32_bf16 v[236:239], v[156:159], v[144:147], v[236:239]
    v_mfma_f32_16x16x32_bf16 v[244:247], v[144:147], v[144:147], v[244:247]
    v_mfma_f32_16x16x32_bf16 v[240:243], v[156:159], v[148:151], v[240:243]
    ds_read_b128 v[228:231], v233
    v_mfma_f32_16x16x32_bf16 v[248:251], v[148:151], v[148:151], v[248:251]
    s_waitcnt lgkmcnt(0)
    v_min3_u32 v228, v228, v229, v230
    v_min_u32 v228, v228, v231
    v_cmp_gt_u32 vcc, 4, v228
    s_nop 1
    s_cbranch_vccz L_sd_13
L_sy_12:
    ds_read_b128 v[228:231], v233
    s_waitcnt lgkmcnt(0)
    v_min3_u32 v228, v228, v229, v230
    v_min_u32 v228, v228, v231
    v_cmp_gt_u32 vcc, 4, v228
    s_nop 1
    s_cbranch_vccnz L_sy_12
L_sd_13:
    v_mfma_f32_16x16x32_bf16 v[16:19], v[112:115], v[144:147], v[16:19]
    ds_read_b128 v[136:139], v164 offset:49152
    ds_read_b128 v[140:143], v164 offset:51200
    ds_read_b64_tr_b16 v[88:89], v166 offset:36864
    v_mfma_f32_16x16x32_bf16 v[40:43], v[112:115], v[148:151], v[40:43]
    ds_read_b64_tr_b16 v[90:91], v166 offset:37632
    ds_read_b64_tr_b16 v[92:93], v167 offset:36896
    ds_read_b64_tr_b16 v[94:95], v167 offset:37664
    v_mfma_f32_16x16x32_bf16 v[20:23], v[116:119], v[144:147], v[20:23]
    ds_read_b64_tr_b16 v[96:97], v166 offset:36928
    ds_read_b64_tr_b16 v[98:99], v166 offset:37696
    ds_read_b64_tr_b16 v[100:101], v167 offset:36960
    v_mfma_f32_16x16x32_bf16 v[44:47], v[116:119], v[148:151], v[44:47]
    ds_read_b64_tr_b16 v[102:103], v167 offset:37728
    ds_read_b64_tr_b16 v[104:105], v166 offset:36992
    ds_read_b64_tr_b16 v[106:107], v166 offset:37760
    v_mfma_f32_16x16x32_bf16 v[24:27], v[120:123], v[144:147], v[24:27]
    ds_read_b64_tr_b16 v[108:109], v167 offset:37024
    ds_read_b64_tr_b16 v[110:111], v167 offset:37792
    s_add_u32 m0, s30, 24576
    s_mov_b32 s41, 1179648
    buffer_load_dwordx4 v160, s[12:15], s41 offen lds
    v_mfma_f32_16x16x32_bf16 v[48:51], v[120:123], v[148:151], v[48:51]
    s_add_u32 m0, s30, 25600
    s_mov_b32 s41, 1179648
    buffer_load_dwordx4 v161, s[12:15], s41 offen lds
    v_mfma_f32_16x16x32_bf16 v[28:31], v[124:127], v[144:147], v[28:31]
    s_add_u32 m0, s30, 26624
    s_mov_b32 s41, 1179648
    buffer_load_dwordx4 v162, s[12:15], s41 offen lds
    v_mfma_f32_16x16x32_bf16 v[52:55], v[124:127], v[148:151], v[52:55]
    s_add_u32 m0, s31, 81920
    s_mov_b32 s41, 768
    buffer_load_dwordx4 v163, s[8:11], s41 offen lds
    v_mfma_f32_16x16x32_bf16 v[32:35], v[128:131], v[144:147], v[32:35]
    s_add_u32 m0, s31, 82944
    s_mov_b32 s41, 11008
    buffer_load_dwordx4 v163, s[8:11], s41 offen lds
    v_mfma_f32_16x16x32_bf16 v[56:59], v[128:131], v[148:151], v[56:59]
    s_add_u32 m0, s31, 83968
    s_mov_b32 s41, 21248
    buffer_load_dwordx4 v163, s[8:11], s41 offen lds
    v_mfma_f32_16x16x32_bf16 v[36:39], v[132:135], v[144:147], v[36:39]
    s_add_u32 m0, s31, 84992
    s_mov_b32 s41, 31488
    buffer_load_dwordx4 v163, s[8:11], s41 offen lds
    v_mfma_f32_16x16x32_bf16 v[60:63], v[132:135], v[148:151], v[60:63]
    s_cmp_lg_u32 s24, 1
    s_cbranch_scc1 L_cs_14
    v_mfma_f32_16x16x32_bf16 v[64:67], v[112:115], v[156:159], v[64:67]
    v_mfma_f32_16x16x32_bf16 v[68:71], v[116:119], v[156:159], v[68:71]
    v_mfma_f32_16x16x32_bf16 v[72:75], v[120:123], v[156:159], v[72:75]
    v_mfma_f32_16x16x32_bf16 v[76:79], v[124:127], v[156:159], v[76:79]
    v_mfma_f32_16x16x32_bf16 v[80:83], v[128:131], v[156:159], v[80:83]
    v_mfma_f32_16x16x32_bf16 v[84:87], v[132:135], v[156:159], v[84:87]
L_cs_14:
    s_waitcnt lgkmcnt(0)
    v_mfma_f32_16x16x32_bf16 v[236:239], v[156:159], v[136:139], v[236:239]
    v_mfma_f32_16x16x32_bf16 v[244:247], v[136:139], v[136:139], v[244:247]
    v_mfma_f32_16x16x32_bf16 v[240:243], v[156:159], v[140:143], v[240:243]
    v_mfma_f32_16x16x32_bf16 v[248:251], v[140:143], v[140:143], v[248:251]
    v_mfma_f32_16x16x32_bf16 v[16:19], v[88:91], v[136:139], v[16:19]
    ds_read_b128 v[144:147], v165 offset:49152
    ds_read_b128 v[148:151], v165 offset:51200
    ds_read_b64_tr_b16 v[112:113], v166 offset:43008
    v_mfma_f32_16x16x32_bf16 v[40:43], v[88:91], v[140:143], v[40:43]
    ds_read_b64_tr_b16 v[114:115], v166 offset:43776
    ds_read_b64_tr_b16 v[116:117], v167 offset:43040
    ds_read_b64_tr_b16 v[118:119], v167 offset:43808
    v_mfma_f32_16x16x32_bf16 v[20:23], v[92:95], v[136:139], v[20:23]
    ds_read_b64_tr_b16 v[120:121], v166 offset:43072
    ds_read_b64_tr_b16 v[122:123], v166 offset:43840
    ds_read_b64_tr_b16 v[124:125], v167 offset:43104
    v_mfma_f32_16x16x32_bf16 v[44:47], v[92:95], v[140:143], v[44:47]
    ds_read_b64_tr_b16 v[126:127], v167 offset:43872
    ds_read_b64_tr_b16 v[128:129], v166 offset:43136
    ds_read_b64_tr_b16 v[130:131], v166 offset:43904
    v_mfma_f32_16x16x32_bf16 v[24:27], v[96:99], v[136:139], v[24:27]
    ds_read_b64_tr_b16 v[132:133], v167 offset:43168
    ds_read_b64_tr_b16 v[134:135], v167 offset:43936
    v_mfma_f32_16x16x32_bf16 v[48:51], v[96:99], v[140:143], v[48:51]
    v_mfma_f32_16x16x32_bf16 v[28:31], v[100:103], v[136:139], v[28:31]
    v_mfma_f32_16x16x32_bf16 v[52:55], v[100:103], v[140:143], v[52:55]
    v_mfma_f32_16x16x32_bf16 v[32:35], v[104:107], v[136:139], v[32:35]
    v_mfma_f32_16x16x32_bf16 v[56:59], v[104:107], v[140:143], v[56:59]
    v_mfma_f32_16x16x32_bf16 v[36:39], v[108:111], v[136:139], v[36:39]
    v_mfma_f32_16x16x32_bf16 v[60:63], v[108:111], v[140:143], v[60:63]
    s_cmp_lg_u32 s24, 2
    s_cbranch_scc1 L_cs_15
    v_mfma_f32_16x16x32_bf16 v[64:67], v[88:91], v[156:159], v[64:67]
    v_mfma_f32_16x16x32_bf16 v[68:71], v[92:95], v[156:159], v[68:71]
    v_mfma_f32_16x16x32_bf16 v[72:75], v[96:99], v[156:159], v[72:75]
    v_mfma_f32_16x16x32_bf16 v[76:79], v[100:103], v[156:159], v[76:79]
    v_mfma_f32_16x16x32_bf16 v[80:83], v[104:107], v[156:159], v[80:83]
    v_mfma_f32_16x16x32_bf16 v[84:87], v[108:111], v[156:159], v[84:87]
L_cs_15:
    s_waitcnt lgkmcnt(0)
    s_waitcnt vmcnt(14)
    v_mov_b32 v234, 5
    s_mov_b64 exec, 1
    ds_write_b32 v232, v234
    s_mov_b64 exec, -1
    v_mfma_f32_16x16x32_bf16 v[236:239], v[156:159], v[144:147], v[236:239]
    v_mfma_f32_16x16x32_bf16 v[244:247], v[144:147], v[144:147], v[244:247]
    v_mfma_f32_16x16x32_bf16 v[240:243], v[156:159], v[148:151], v[240:243]
    ds_read_b128 v[228:231], v233
    v_mfma_f32_16x16x32_bf16 v[248:251], v[148:151], v[148:151], v[248:251]
    s_waitcnt lgkmcnt(0)
    v_min3_u32 v228, v228, v229, v230
    v_min_u32 v228, v228, v231
    v_cmp_gt_u32 vcc, 5, v228
    s_nop 1
    s_cbranch_vccz L_sd_17
L_sy_16:
    ds_read_b128 v[228:231], v233
    s_waitcnt lgkmcnt(0)
    v_min3_u32 v228, v228, v229, v230
    v_min_u32 v228, v228, v231
    v_cmp_gt_u32 vcc, 5, v228
    s_nop 1
    s_cbranch_vccnz L_sy_16
L_sd_17:
    v_mfma_f32_16x16x32_bf16 v[16:19], v[112:115], v[144:147], v[16:19]
    ds_read_b128 v[136:139], v164 offset:0
    ds_read_b128 v[140:143], v164 offset:2048
    ds_read_b64_tr_b16 v[88:89], v166 offset:0
    v_mfma_f32_16x16x32_bf16 v[40:43], v[112:115], v[148:151], v[40:43]
    ds_read_b64_tr_b16 v[90:91], v166 offset:768
    ds_read_b64_tr_b16 v[92:93], v167 offset:32
    ds_read_b64_tr_b16 v[94:95], v167 offset:800
    v_mfma_f32_16x16x32_bf16 v[20:23], v[116:119], v[144:147], v[20:23]
    ds_read_b64_tr_b16 v[96:97], v166 offset:64
    ds_read_b64_tr_b16 v[98:99], v166 offset:832
    ds_read_b64_tr_b16 v[100:101], v167 offset:96
    v_mfma_f32_16x16x32_bf16 v[44:47], v[116:119], v[148:151], v[44:47]
    ds_read_b64_tr_b16 v[102:103], v167 offset:864
    ds_read_b64_tr_b16 v[104:105], v166 offset:128
    ds_read_b64_tr_b16 v[106:107], v166 offset:896
    v_mfma_f32_16x16x32_bf16 v[24:27], v[120:123], v[144:147], v[24:27]
    ds_read_b64_tr_b16 v[108:109], v167 offset:160
    ds_read_b64_tr_b16 v[110:111], v167 offset:928
    s_add_u32 m0, s30, 36864
    s_mov_b32 s41, 1376256
    buffer_load_dwordx4 v160, s[12:15], s41 offen lds
    v_mfma_f32_16x16x32_bf16 v[48:51], v[120:123], v[148:151], v[48:51]
    s_add_u32 m0, s30, 37888
    s_mov_b32 s41, 1376256
    buffer_load_dwordx4 v161, s[12:15], s41 offen lds
    v_mfma_f32_16x16x32_bf16 v[28:31], v[124:127], v[144:147], v[28:31]
    s_add_u32 m0, s30, 38912
    s_mov_b32 s41, 1376256
    buffer_load_dwordx4 v162, s[12:15], s41 offen lds
    v_mfma_f32_16x16x32_bf16 v[52:55], v[124:127], v[148:151], v[52:55]
    s_add_u32 m0, s31, 98304
    s_mov_b32 s41, 896
    buffer_load_dwordx4 v163, s[8:11], s41 offen lds
    v_mfma_f32_16x16x32_bf16 v[32:35], v[128:131], v[144:147], v[32:35]
    s_add_u32 m0, s31, 99328
    s_mov_b32 s41, 11136
    buffer_load_dwordx4 v163, s[8:11], s41 offen lds
    v_mfma_f32_16x16x32_bf16 v[56:59], v[128:131], v[148:151], v[56:59]
    s_add_u32 m0, s31, 100352
    s_mov_b32 s41, 21376
    buffer_load_dwordx4 v163, s[8:11], s41 offen lds
    v_mfma_f32_16x16x32_bf16 v[36:39], v[132:135], v[144:147], v[36:39]
    s_add_u32 m0, s31, 101376
    s_mov_b32 s41, 31616
    buffer_load_dwordx4 v163, s[8:11], s41 offen lds
    v_mfma_f32_16x16x32_bf16 v[60:63], v[132:135], v[148:151], v[60:63]
    s_cmp_lg_u32 s24, 3
    s_cbranch_scc1 L_cs_18
    v_mfma_f32_16x16x32_bf16 v[64:67], v[112:115], v[156:159], v[64:67]
    v_mfma_f32_16x16x32_bf16 v[68:71], v[116:119], v[156:159], v[68:71]
    v_mfma_f32_16x16x32_bf16 v[72:75], v[120:123], v[156:159], v[72:75]
    v_mfma_f32_16x16x32_bf16 v[76:79], v[124:127], v[156:159], v[76:79]
    v_mfma_f32_16x16x32_bf16 v[80:83], v[128:131], v[156:159], v[80:83]
    v_mfma_f32_16x16x32_bf16 v[84:87], v[132:135], v[156:159], v[84:87]
L_cs_18:
    s_waitcnt lgkmcnt(0)
    v_mfma_f32_16x16x32_bf16 v[236:239], v[156:159], v[136:139], v[236:239]
    v_mfma_f32_16x16x32_bf16 v[244:247], v[136:139], v[136:139], v[244:247]
    v_mfma_f32_16x16x32_bf16 v[240:243], v[156:159], v[140:143], v[240:243]
    v_mfma_f32_16x16x32_bf16 v[248:251], v[140:143], v[140:143], v[248:251]
    v_mfma_f32_16x16x32_bf16 v[16:19], v[88:91], v[136:139], v[16:19]
    ds_read_b128 v[144:147], v165 offset:0
    ds_read_b128 v[148:151], v165 offset:2048
    ds_read_b64_tr_b16 v[112:113], v166 offset:6144
    v_mfma_f32_16x16x32_bf16 v[40:43], v[88:91], v[140:143], v[40:43]
    ds_read_b64_tr_b16 v[114:115], v166 offset:6912
    ds_read_b64_tr_b16 v[116:117], v167 offset:6176
    ds_read_b64_tr_b16 v[118:119], v167 offset:6944
    v_mfma_f32_16x16x32_bf16 v[20:23], v[92:95], v[136:139], v[20:23]
    ds_read_b64_tr_b16 v[120:121], v166 offset:6208
    ds_read_b64_tr_b16 v[122:123], v166 offset:6976
    ds_read_b64_tr_b16 v[124:125], v167 offset:6240
    v_mfma_f32_16x16x32_bf16 v[44:47], v[92:95], v[140:143], v[44:47]
    ds_read_b64_tr_b16 v[126:127], v167 offset:7008
    ds_read_b64_tr_b16 v[128:129], v166 offset:6272
    ds_read_b64_tr_b16 v[130:131], v166 offset:7040
    v_mfma_f32_16x16x32_bf16 v[24:27], v[96:99], v[136:139], v[24:27]
    ds_read_b64_tr_b16 v[132:133], v167 offset:6304
    ds_read_b64_tr_b16 v[134:135], v167 offset:7072
    v_mfma_f32_16x16x32_bf16 v[48:51], v[96:99], v[140:143], v[48:51]
    v_mfma_f32_16x16x32_bf16 v[28:31], v[100:103], v[136:139], v[28:31]
    v_mfma_f32_16x16x32_bf16 v[52:55], v[100:103], v[140:143], v[52:55]
    v_mfma_f32_16x16x32_bf16 v[32:35], v[104:107], v[136:139], v[32:35]
    v_mfma_f32_16x16x32_bf16 v[56:59], v[104:107], v[140:143], v[56:59]
    v_mfma_f32_16x16x32_bf16 v[36:39], v[108:111], v[136:139], v[36:39]
    v_mfma_f32_16x16x32_bf16 v[60:63], v[108:111], v[140:143], v[60:63]
    s_cmp_lg_u32 s24, 0
    s_cbranch_scc1 L_cs_19
    v_mfma_f32_16x16x32_bf16 v[64:67], v[88:91], v[156:159], v[64:67]
    v_mfma_f32_16x16x32_bf16 v[68:71], v[92:95], v[156:159], v[68:71]
    v_mfma_f32_16x16x32_bf16 v[72:75], v[96:99], v[156:159], v[72:75]
    v_mfma_f32_16x16x32_bf16 v[76:79], v[100:103], v[156:159], v[76:79]
    v_mfma_f32_16x16x32_bf16 v[80:83], v[104:107], v[156:159], v[80:83]
    v_mfma_f32_16x16x32_bf16 v[84:87], v[108:111], v[156:159], v[84:87]
L_cs_19:
    s_waitcnt lgkmcnt(0)
    s_waitcnt vmcnt(14)
    v_mov_b32 v234, 6
    s_mov_b64 exec, 1
    ds_write_b32 v232, v234
    s_mov_b64 exec, -1
    v_mfma_f32_16x16x32_bf16 v[236:239], v[156:159], v[144:147], v[236:239]
    v_mfma_f32_16x16x32_bf16 v[244:247], v[144:147], v[144:147], v[244:247]
    v_mfma_f32_16x16x32_bf16 v[240:243], v[156:159], v[148:151], v[240:243]
    ds_read_b128 v[228:231], v233
    v_mfma_f32_16x16x32_bf16 v[248:251], v[148:151], v[148:151], v[248:251]
    s_waitcnt lgkmcnt(0)
    v_min3_u32 v228, v228, v229, v230
    v_min_u32 v228, v228, v231
    v_cmp_gt_u32 vcc, 6, v228
    s_nop 1
    s_cbranch_vccz L_sd_21
L_sy_20:
    ds_read_b128 v[228:231], v233
    s_waitcnt lgkmcnt(0)
    v_min3_u32 v228, v228, v229, v230
    v_min_u32 v228, v228, v231
    v_cmp_gt_u32 vcc, 6, v228
    s_nop 1
    s_cbranch_vccnz L_sy_20
L_sd_21:
    v_mfma_f32_16x16x32_bf16 v[16:19], v[112:115], v[144:147], v[16:19]
    ds_read_b128 v[136:139], v164 offset:16384
    ds_read_b128 v[140:143], v164 offset:18432
    ds_read_b64_tr_b16 v[88:89], v166 offset:12288
    v_mfma_f32_16x16x32_bf16 v[40:43], v[112:115], v[148:151], v[40:43]
    ds_read_b64_tr_b16 v[90:91], v166 offset:13056
    ds_read_b64_tr_b16 v[92:93], v167 offset:12320
    ds_read_b64_tr_b16 v[94:95], v167 offset:13088
    v_mfma_f32_16x16x32_bf16 v[20:23], v[116:119], v[144:147], v[20:23]
    ds_read_b64_tr_b16 v[96:97], v166 offset:12352
    ds_read_b64_tr_b16 v[98:99], v166 offset:13120
    ds_read_b64_tr_b16 v[100:101], v167 offset:12384
    v_mfma_f32_16x16x32_bf16 v[44:47], v[116:119], v[148:151], v[44:47]
    ds_read_b64_tr_b16 v[102:103], v167 offset:13152
    ds_read_b64_tr_b16 v[104:105], v166 offset:12416
    ds_read_b64_tr_b16 v[106:107], v166 offset:13184
    v_mfma_f32_16x16x32_bf16 v[24:27], v[120:123], v[144:147], v[24:27]
    ds_read_b64_tr_b16 v[108:109], v167 offset:12448
    ds_read_b64_tr_b16 v[110:111], v167 offset:13216
    s_add_u32 m0, s30, 0
    s_mov_b32 s41, 1572864
    buffer_load_dwordx4 v160, s[12:15], s41 offen lds
    v_mfma_f32_16x16x32_bf16 v[48:51], v[120:123], v[148:151], v[48:51]
    s_add_u32 m0, s30, 1024
    s_mov_b32 s41, 1572864
    buffer_load_dwordx4 v161, s[12:15], s41 offen lds
    v_mfma_f32_16x16x32_bf16 v[28:31], v[124:127], v[144:147], v[28:31]
    s_add_u32 m0, s30, 2048
    s_mov_b32 s41, 1572864
    buffer_load_dwordx4 v162, s[12:15], s41 offen lds
    v_mfma_f32_16x16x32_bf16 v[52:55], v[124:127], v[148:151], v[52:55]
    s_add_u32 m0, s31, 49152
    s_mov_b32 s41, 1024
    buffer_load_dwordx4 v163, s[8:11], s41 offen lds
    v_mfma_f32_16x16x32_bf16 v[32:35], v[128:131], v[144:147], v[32:35]
    s_add_u32 m0, s31, 50176
    s_mov_b32 s41, 11264
    buffer_load_dwordx4 v163, s[8:11], s41 offen lds
    v_mfma_f32_16x16x32_bf16 v[56:59], v[128:131], v[148:151], v[56:59]
    s_add_u32 m0, s31, 51200
    s_mov_b32 s41, 21504
    buffer_load_dwordx4 v163, s[8:11], s41 offen lds
    v_mfma_f32_16x16x32_bf16 v[36:39], v[132:135], v[144:147], v[36:39]
    s_add_u32 m0, s31, 52224
    s_mov_b32 s41, 31744
    buffer_load_dwordx4 v163, s[8:11], s41 offen lds
    v_mfma_f32_16x16x32_bf16 v[60:63], v[132:135], v[148:151], v[60:63]
    s_cmp_lg_u32 s24, 1
    s_cbranch_scc1 L_cs_22
    v_mfma_f32_16x16x32_bf16 v[64:67], v[112:115], v[156:159], v[64:67]
    v_mfma_f32_16x16x32_bf16 v[68:71], v[116:119], v[156:159], v[68:71]
    v_mfma_f32_16x16x32_bf16 v[72:75], v[120:123], v[156:159], v[72:75]
    v_mfma_f32_16x16x32_bf16 v[76:79], v[124:127], v[156:159], v[76:79]
    v_mfma_f32_16x16x32_bf16 v[80:83], v[128:131], v[156:159], v[80:83]
    v_mfma_f32_16x16x32_bf16 v[84:87], v[132:135], v[156:159], v[84:87]
L_cs_22:
    s_waitcnt lgkmcnt(0)
    v_mfma_f32_16x16x32_bf16 v[236:239], v[156:159], v[136:139], v[236:239]
    v_mfma_f32_16x16x32_bf16 v[244:247], v[136:139], v[136:139], v[244:247]
    v_mfma_f32_16x16x32_bf16 v[240:243], v[156:159], v[140:143], v[240:243]
    v_mfma_f32_16x16x32_bf16 v[248:251], v[140:143], v[140:143], v[248:251]
    v_mfma_f32_16x16x32_bf16 v[16:19], v[88:91], v[136:139], v[16:19]
    ds_read_b128 v[144:147], v165 offset:16384
    ds_read_b128 v[148:151], v165 offset:18432
    ds_read_b64_tr_b16 v[112:113], v166 offset:18432
    v_mfma_f32_16x16x32_bf16 v[40:43], v[88:91], v[140:143], v[40:43]
    ds_read_b64_tr_b16 v[114:115], v166 offset:19200
    ds_read_b64_tr_b16 v[116:117], v167 offset:18464
    ds_read_b64_tr_b16 v[118:119], v167 offset:19232
    v_mfma_f32_16x16x32_bf16 v[20:23], v[92:95], v[136:139], v[20:23]
    ds_read_b64_tr_b16 v[120:121], v166 offset:18496
    ds_read_b64_tr_b16 v[122:123], v166 offset:19264
    ds_read_b64_tr_b16 v[124:125], v167 offset:18528
    v_mfma_f32_16x16x32_bf16 v[44:47], v[92:95], v[140:143], v[44:47]
    ds_read_b64_tr_b16 v[126:127], v167 offset:19296
    ds_read_b64_tr_b16 v[128:129], v166 offset:18560
    ds_read_b64_tr_b16 v[130:131], v166 offset:19328
    v_mfma_f32_16x16x32_bf16 v[24:27], v[96:99], v[136:139], v[24:27]
    ds_read_b64_tr_b16 v[132:133], v167 offset:18592
    ds_read_b64_tr_b16 v[134:135], v167 offset:19360
    v_mfma_f32_16x16x32_bf16 v[48:51], v[96:99], v[140:143], v[48:51]
    v_mfma_f32_16x16x32_bf16 v[28:31], v[100:103], v[136:139], v[28:31]
    v_mfma_f32_16x16x32_bf16 v[52:55], v[100:103], v[140:143], v[52:55]
    v_mfma_f32_16x16x32_bf16 v[32:35], v[104:107], v[136:139], v[32:35]
    v_mfma_f32_16x16x32_bf16 v[56:59], v[104:107], v[140:143], v[56:59]
    v_mfma_f32_16x16x32_bf16 v[36:39], v[108:111], v[136:139], v[36:39]
    v_mfma_f32_16x16x32_bf16 v[60:63], v[108:111], v[140:143], v[60:63]
    s_cmp_lg_u32 s24, 2
    s_cbranch_scc1 L_cs_23
    v_mfma_f32_16x16x32_bf16 v[64:67], v[88:91], v[156:159], v[64:67]
    v_mfma_f32_16x16x32_bf16 v[68:71], v[92:95], v[156:159], v[68:71]
    v_mfma_f32_16x16x32_bf16 v[72:75], v[96:99], v[156:159], v[72:75]
    v_mfma_f32_16x16x32_bf16 v[76:79], v[100:103], v[156:159], v[76:79]
    v_mfma_f32_16x16x32_bf16 v[80:83], v[104:107], v[156:159], v[80:83]
    v_mfma_f32_16x16x32_bf16 v[84:87], v[108:111], v[156:159], v[84:87]
L_cs_23:
    s_waitcnt lgkmcnt(0)
    s_waitcnt vmcnt(14)
    v_mov_b32 v234, 7
    s_mov_b64 exec, 1
    ds_write_b32 v232, v234
    s_mov_b64 exec, -1
    v_mfma_f32_16x16x32_bf16 v[236:239], v[156:159], v[144:147], v[236:239]
    v_mfma_f32_16x16x32_bf16 v[244:247], v[144:147], v[144:147], v[244:247]
    v_mfma_f32_16x16x32_bf16 v[240:243], v[156:159], v[148:151], v[240:243]
    ds_read_b128 v[228:231], v233
    v_mfma_f32_16x16x32_bf16 v[248:251], v[148:151], v[148:151], v[248:251]
    s_waitcnt lgkmcnt(0)
    v_min3_u32 v228, v228, v229, v230
    v_min_u32 v228, v228, v231
    v_cmp_gt_u32 vcc, 7, v228
    s_nop 1
    s_cbranch_vccz L_sd_25
L_sy_24:
    ds_read_b128 v[228:231], v233
    s_waitcnt lgkmcnt(0)
    v_min3_u32 v228, v228, v229, v230
    v_min_u32 v228, v228, v231
    v_cmp_gt_u32 vcc, 7, v228
    s_nop 1
    s_cbranch_vccnz L_sy_24
L_sd_25:
    v_mfma_f32_16x16x32_bf16 v[16:19], v[112:115], v[144:147], v[16:19]
    ds_read_b128 v[136:139], v164 offset:32768
    ds_read_b128 v[140:143], v164 offset:34816
    ds_read_b64_tr_b16 v[88:89], v166 offset:24576
    v_mfma_f32_16x16x32_bf16 v[40:43], v[112:115], v[148:151], v[40:43]
    ds_read_b64_tr_b16 v[90:91], v166 offset:25344
    ds_read_b64_tr_b16 v[92:93], v167 offset:24608
    ds_read_b64_tr_b16 v[94:95], v167 offset:25376
    v_mfma_f32_16x16x32_bf16 v[20:23], v[116:119], v[144:147], v[20:23]
    ds_read_b64_tr_b16 v[96:97], v166 offset:24640
    ds_read_b64_tr_b16 v[98:99], v166 offset:25408
    ds_read_b64_tr_b16 v[100:101], v167 offset:24672
    v_mfma_f32_16x16x32_bf16 v[44:47], v[116:119], v[148:151], v[44:47]
    ds_read_b64_tr_b16 v[102:103], v167 offset:25440
    ds_read_b64_tr_b16 v[104:105], v166 offset:24704
    ds_read_b64_tr_b16 v[106:107], v166 offset:25472
    v_mfma_f32_16x16x32_bf16 v[24:27], v[120:123], v[144:147], v[24:27]
    ds_read_b64_tr_b16 v[108:109], v167 offset:24736
    ds_read_b64_tr_b16 v[110:111], v167 offset:25504
    s_add_u32 m0, s30, 12288
    s_mov_b32 s41, 1769472
    buffer_load_dwordx4 v160, s[12:15], s41 offen lds
    v_mfma_f32_16x16x32_bf16 v[48:51], v[120:123], v[148:151], v[48:51]
    s_add_u32 m0, s30, 13312
    s_mov_b32 s41, 1769472
    buffer_load_dwordx4 v161, s[12:15], s41 offen lds
    v_mfma_f32_16x16x32_bf16 v[28:31], v[124:127], v[144:147], v[28:31]
    s_add_u32 m0, s30, 14336
    s_mov_b32 s41, 1769472
    buffer_load_dwordx4 v162, s[12:15], s41 offen lds
    v_mfma_f32_16x16x32_bf16 v[52:55], v[124:127], v[148:151], v[52:55]
    s_add_u32 m0, s31, 65536
    s_mov_b32 s41, 1152
    buffer_load_dwordx4 v163, s[8:11], s41 offen lds
    v_mfma_f32_16x16x32_bf16 v[32:35], v[128:131], v[144:147], v[32:35]
    s_add_u32 m0, s31, 66560
    s_mov_b32 s41, 11392
    buffer_load_dwordx4 v163, s[8:11], s41 offen lds
    v_mfma_f32_16x16x32_bf16 v[56:59], v[128:131], v[148:151], v[56:59]
    s_add_u32 m0, s31, 67584
    s_mov_b32 s41, 21632
    buffer_load_dwordx4 v163, s[8:11], s41 offen lds
    v_mfma_f32_16x16x32_bf16 v[36:39], v[132:135], v[144:147], v[36:39]
    s_add_u32 m0, s31, 68608
    s_mov_b32 s41, 31872
    buffer_load_dwordx4 v163, s[8:11], s41 offen lds
    v_mfma_f32_16x16x32_bf16 v[60:63], v[132:135], v[148:151], v[60:63]
    s_cmp_lg_u32 s24, 3
    s_cbranch_scc1 L_cs_26
    v_mfma_f32_16x16x32_bf16 v[64:67], v[112:115], v[156:159], v[64:67]
    v_mfma_f32_16x16x32_bf16 v[68:71], v[116:119], v[156:159], v[68:71]
    v_mfma_f32_16x16x32_bf16 v[72:75], v[120:123], v[156:159], v[72:75]
    v_mfma_f32_16x16x32_bf16 v[76:79], v[124:127], v[156:159], v[76:79]
    v_mfma_f32_16x16x32_bf16 v[80:83], v[128:131], v[156:159], v[80:83]
    v_mfma_f32_16x16x32_bf16 v[84:87], v[132:135], v[156:159], v[84:87]
L_cs_26:
    s_waitcnt lgkmcnt(0)
    v_mfma_f32_16x16x32_bf16 v[236:239], v[156:159], v[136:139], v[236:239]
    v_mfma_f32_16x16x32_bf16 v[244:247], v[136:139], v[136:139], v[244:247]
    v_mfma_f32_16x16x32_bf16 v[240:243], v[156:159], v[140:143], v[240:243]
    v_mfma_f32_16x16x32_bf16 v[248:251], v[140:143], v[140:143], v[248:251]
    v_mfma_f32_16x16x32_bf16 v[16:19], v[88:91], v[136:139], v[16:19]
    ds_read_b128 v[144:147], v165 offset:32768
    ds_read_b128 v[148:151], v165 offset:34816
    ds_read_b64_tr_b16 v[112:113], v166 offset:30720
    v_mfma_f32_16x16x32_bf16 v[40:43], v[88:91], v[140:143], v[40:43]
    ds_read_b64_tr_b16 v[114:115], v166 offset:31488
    ds_read_b64_tr_b16 v[116:117], v167 offset:30752
    ds_read_b64_tr_b16 v[118:119], v167 offset:31520
    v_mfma_f32_16x16x32_bf16 v[20:23], v[92:95], v[136:139], v[20:23]
    ds_read_b64_tr_b16 v[120:121], v166 offset:30784
    ds_read_b64_tr_b16 v[122:123], v166 offset:31552
    ds_read_b64_tr_b16 v[124:125], v167 offset:30816
    v_mfma_f32_16x16x32_bf16 v[44:47], v[92:95], v[140:143], v[44:47]
    ds_read_b64_tr_b16 v[126:127], v167 offset:31584
    ds_read_b64_tr_b16 v[128:129], v166 offset:30848
    ds_read_b64_tr_b16 v[130:131], v166 offset:31616
    v_mfma_f32_16x16x32_bf16 v[24:27], v[96:99], v[136:139], v[24:27]
    ds_read_b64_tr_b16 v[132:133], v167 offset:30880
    ds_read_b64_tr_b16 v[134:135], v167 offset:31648
    v_mfma_f32_16x16x32_bf16 v[48:51], v[96:99], v[140:143], v[48:51]
    v_mfma_f32_16x16x32_bf16 v[28:31], v[100:103], v[136:139], v[28:31]
    v_mfma_f32_16x16x32_bf16 v[52:55], v[100:103], v[140:143], v[52:55]
    v_mfma_f32_16x16x32_bf16 v[32:35], v[104:107], v[136:139], v[32:35]
    v_mfma_f32_16x16x32_bf16 v[56:59], v[104:107], v[140:143], v[56:59]
    v_mfma_f32_16x16x32_bf16 v[36:39], v[108:111], v[136:139], v[36:39]
    v_mfma_f32_16x16x32_bf16 v[60:63], v[108:111], v[140:143], v[60:63]
    s_cmp_lg_u32 s24, 0
    s_cbranch_scc1 L_cs_27
    v_mfma_f32_16x16x32_bf16 v[64:67], v[88:91], v[156:159], v[64:67]
    v_mfma_f32_16x16x32_bf16 v[68:71], v[92:95], v[156:159], v[68:71]
    v_mfma_f32_16x16x32_bf16 v[72:75], v[96:99], v[156:159], v[72:75]
    v_mfma_f32_16x16x32_bf16 v[76:79], v[100:103], v[156:159], v[76:79]
    v_mfma_f32_16x16x32_bf16 v[80:83], v[104:107], v[156:159], v[80:83]
    v_mfma_f32_16x16x32_bf16 v[84:87], v[108:111], v[156:159], v[84:87]
L_cs_27:
    s_waitcnt lgkmcnt(0)
    s_waitcnt vmcnt(14)
    v_mov_b32 v234, 8
    s_mov_b64 exec, 1
    ds_write_b32 v232, v234
    s_mov_b64 exec, -1
    v_mfma_f32_16x16x32_bf16 v[236:239], v[156:159], v[144:147], v[236:239]
    v_mfma_f32_16x16x32_bf16 v[244:247], v[144:147], v[144:147], v[244:247]
    v_mfma_f32_16x16x32_bf16 v[240:243], v[156:159], v[148:151], v[240:243]
    ds_read_b128 v[228:231], v233
    v_mfma_f32_16x16x32_bf16 v[248:251], v[148:151], v[148:151], v[248:251]
    s_waitcnt lgkmcnt(0)
    v_min3_u32 v228, v228, v229, v230
    v_min_u32 v228, v228, v231
    v_cmp_gt_u32 vcc, 8, v228
    s_nop 1
    s_cbranch_vccz L_sd_29
L_sy_28:
    ds_read_b128 v[228:231], v233
    s_waitcnt lgkmcnt(0)
    v_min3_u32 v228, v228, v229, v230
    v_min_u32 v228, v228, v231
    v_cmp_gt_u32 vcc, 8, v228
    s_nop 1
    s_cbranch_vccnz L_sy_28
L_sd_29:
    v_mfma_f32_16x16x32_bf16 v[16:19], v[112:115], v[144:147], v[16:19]
    ds_read_b128 v[136:139], v164 offset:49152
    ds_read_b128 v[140:143], v164 offset:51200
    ds_read_b64_tr_b16 v[88:89], v166 offset:36864
    v_mfma_f32_16x16x32_bf16 v[40:43], v[112:115], v[148:151], v[40:43]
    ds_read_b64_tr_b16 v[90:91], v166 offset:37632
    ds_read_b64_tr_b16 v[92:93], v167 offset:36896
    ds_read_b64_tr_b16 v[94:95], v167 offset:37664
    v_mfma_f32_16x16x32_bf16 v[20:23], v[116:119], v[144:147], v[20:23]
    ds_read_b64_tr_b16 v[96:97], v166 offset:36928
    ds_read_b64_tr_b16 v[98:99], v166 offset:37696
    ds_read_b64_tr_b16 v[100:101], v167 offset:36960
    v_mfma_f32_16x16x32_bf16 v[44:47], v[116:119], v[148:151], v[44:47]
    ds_read_b64_tr_b16 v[102:103], v167 offset:37728
    ds_read_b64_tr_b16 v[104:105], v166 offset:36992
    ds_read_b64_tr_b16 v[106:107], v166 offset:37760
    v_mfma_f32_16x16x32_bf16 v[24:27], v[120:123], v[144:147], v[24:27]
    ds_read_b64_tr_b16 v[108:109], v167 offset:37024
    ds_read_b64_tr_b16 v[110:111], v167 offset:37792
    v_mfma_f32_16x16x32_bf16 v[48:51], v[120:123], v[148:151], v[48:51]
    v_mfma_f32_16x16x32_bf16 v[28:31], v[124:127], v[144:147], v[28:31]
    v_mfma_f32_16x16x32_bf16 v[52:55], v[124:127], v[148:151], v[52:55]
    v_mfma_f32_16x16x32_bf16 v[32:35], v[128:131], v[144:147], v[32:35]
    v_mfma_f32_16x16x32_bf16 v[56:59], v[128:131], v[148:151], v[56:59]
    v_mfma_f32_16x16x32_bf16 v[36:39], v[132:135], v[144:147], v[36:39]
    v_mfma_f32_16x16x32_bf16 v[60:63], v[132:135], v[148:151], v[60:63]
    s_cmp_lg_u32 s24, 1
    s_cbranch_scc1 L_cs_30
    v_mfma_f32_16x16x32_bf16 v[64:67], v[112:115], v[156:159], v[64:67]
    v_mfma_f32_16x16x32_bf16 v[68:71], v[116:119], v[156:159], v[68:71]
    v_mfma_f32_16x16x32_bf16 v[72:75], v[120:123], v[156:159], v[72:75]
    v_mfma_f32_16x16x32_bf16 v[76:79], v[124:127], v[156:159], v[76:79]
    v_mfma_f32_16x16x32_bf16 v[80:83], v[128:131], v[156:159], v[80:83]
    v_mfma_f32_16x16x32_bf16 v[84:87], v[132:135], v[156:159], v[84:87]
L_cs_30:
    s_waitcnt lgkmcnt(0)
    v_mfma_f32_16x16x32_bf16 v[236:239], v[156:159], v[136:139], v[236:239]
    v_mfma_f32_16x16x32_bf16 v[244:247], v[136:139], v[136:139], v[244:247]
    v_mfma_f32_16x16x32_bf16 v[240:243], v[156:159], v[140:143], v[240:243]
    v_mfma_f32_16x16x32_bf16 v[248:251], v[140:143], v[140:143], v[248:251]
    v_mfma_f32_16x16x32_bf16 v[16:19], v[88:91], v[136:139], v[16:19]
    ds_read_b128 v[144:147], v165 offset:49152
    ds_read_b128 v[148:151], v165 offset:51200
    ds_read_b64_tr_b16 v[112:113], v166 offset:43008
    v_mfma_f32_16x16x32_bf16 v[40:43], v[88:91], v[140:143], v[40:43]
    ds_read_b64_tr_b16 v[114:115], v166 offset:43776
    ds_read_b64_tr_b16 v[116:117], v167 offset:43040
    ds_read_b64_tr_b16 v[118:119], v167 offset:43808
    v_mfma_f32_16x16x32_bf16 v[20:23], v[92:95], v[136:139], v[20:23]
    ds_read_b64_tr_b16 v[120:121], v166 offset:43072
    ds_read_b64_tr_b16 v[122:123], v166 offset:43840
    ds_read_b64_tr_b16 v[124:125], v167 offset:43104
    v_mfma_f32_16x16x32_bf16 v[44:47], v[92:95], v[140:143], v[44:47]
    ds_read_b64_tr_b16 v[126:127], v167 offset:43872
    ds_read_b64_tr_b16 v[128:129], v166 offset:43136
    ds_read_b64_tr_b16 v[130:131], v166 offset:43904
    v_mfma_f32_16x16x32_bf16 v[24:27], v[96:99], v[136:139], v[24:27]
    ds_read_b64_tr_b16 v[132:133], v167 offset:43168
    ds_read_b64_tr_b16 v[134:135], v167 offset:43936
    v_mfma_f32_16x16x32_bf16 v[48:51], v[96:99], v[140:143], v[48:51]
    v_mfma_f32_16x16x32_bf16 v[28:31], v[100:103], v[136:139], v[28:31]
    v_mfma_f32_16x16x32_bf16 v[52:55], v[100:103], v[140:143], v[52:55]
    v_mfma_f32_16x16x32_bf16 v[32:35], v[104:107], v[136:139], v[32:35]
    v_mfma_f32_16x16x32_bf16 v[56:59], v[104:107], v[140:143], v[56:59]
    v_mfma_f32_16x16x32_bf16 v[36:39], v[108:111], v[136:139], v[36:39]
    v_mfma_f32_16x16x32_bf16 v[60:63], v[108:111], v[140:143], v[60:63]
    s_cmp_lg_u32 s24, 2
    s_cbranch_scc1 L_cs_31
    v_mfma_f32_16x16x32_bf16 v[64:67], v[88:91], v[156:159], v[64:67]
    v_mfma_f32_16x16x32_bf16 v[68:71], v[92:95], v[156:159], v[68:71]
    v_mfma_f32_16x16x32_bf16 v[72:75], v[96:99], v[156:159], v[72:75]
    v_mfma_f32_16x16x32_bf16 v[76:79], v[100:103], v[156:159], v[76:79]
    v_mfma_f32_16x16x32_bf16 v[80:83], v[104:107], v[156:159], v[80:83]
    v_mfma_f32_16x16x32_bf16 v[84:87], v[108:111], v[156:159], v[84:87]
L_cs_31:
    s_waitcnt lgkmcnt(0)
    s_waitcnt vmcnt(7)
    v_mov_b32 v234, 9
    s_mov_b64 exec, 1
    ds_write_b32 v232, v234
    s_mov_b64 exec, -1
    v_mfma_f32_16x16x32_bf16 v[236:239], v[156:159], v[144:147], v[236:239]
    v_mfma_f32_16x16x32_bf16 v[244:247], v[144:147], v[144:147], v[244:247]
    v_mfma_f32_16x16x32_bf16 v[240:243], v[156:159], v[148:151], v[240:243]
    ds_read_b128 v[228:231], v233
    v_mfma_f32_16x16x32_bf16 v[248:251], v[148:151], v[148:151], v[248:251]
    s_waitcnt lgkmcnt(0)
    v_min3_u32 v228, v228, v229, v230
    v_min_u32 v228, v228, v231
    v_cmp_gt_u32 vcc, 9, v228
    s_nop 1
    s_cbranch_vccz L_sd_33
L_sy_32:
    ds_read_b128 v[228:231], v233
    s_waitcnt lgkmcnt(0)
    v_min3_u32 v228, v228, v229, v230
    v_min_u32 v228, v228, v231
    v_cmp_gt_u32 vcc, 9, v228
    s_nop 1
    s_cbranch_vccnz L_sy_32
L_sd_33:
    v_mfma_f32_16x16x32_bf16 v[16:19], v[112:115], v[144:147], v[16:19]
    ds_read_b128 v[136:139], v164 offset:0
    ds_read_b128 v[140:143], v164 offset:2048
    ds_read_b64_tr_b16 v[88:89], v166 offset:0
    v_mfma_f32_16x16x32_bf16 v[40:43], v[112:115], v[148:151], v[40:43]
    ds_read_b64_tr_b16 v[90:91], v166 offset:768
    ds_read_b64_tr_b16 v[92:93], v167 offset:32
    ds_read_b64_tr_b16 v[94:95], v167 offset:800
    v_mfma_f32_16x16x32_bf16 v[20:23], v[116:119], v[144:147], v[20:23]
    ds_read_b64_tr_b16 v[96:97], v166 offset:64
    ds_read_b64_tr_b16 v[98:99], v166 offset:832
    ds_read_b64_tr_b16 v[100:101], v167 offset:96
    v_mfma_f32_16x16x32_bf16 v[44:47], v[116:119], v[148:151], v[44:47]
    ds_read_b64_tr_b16 v[102:103], v167 offset:864
    ds_read_b64_tr_b16 v[104:105], v166 offset:128
    ds_read_b64_tr_b16 v[106:107], v166 offset:896
    v_mfma_f32_16x16x32_bf16 v[24:27], v[120:123], v[144:147], v[24:27]
    ds_read_b64_tr_b16 v[108:109], v167 offset:160
    ds_read_b64_tr_b16 v[110:111], v167 offset:928
    v_mfma_f32_16x16x32_bf16 v[48:51], v[120:123], v[148:151], v[48:51]
    v_mfma_f32_16x16x32_bf16 v[28:31], v[124:127], v[144:147], v[28:31]
    v_mfma_f32_16x16x32_bf16 v[52:55], v[124:127], v[148:151], v[52:55]
    v_mfma_f32_16x16x32_bf16 v[32:35], v[128:131], v[144:147], v[32:35]
    v_mfma_f32_16x16x32_bf16 v[56:59], v[128:131], v[148:151], v[56:59]
    v_mfma_f32_16x16x32_bf16 v[36:39], v[132:135], v[144:147], v[36:39]
    v_mfma_f32_16x16x32_bf16 v[60:63], v[132:135], v[148:151], v[60:63]
    s_cmp_lg_u32 s24, 3
    s_cbranch_scc1 L_cs_34
    v_mfma_f32_16x16x32_bf16 v[64:67], v[112:115], v[156:159], v[64:67]
    v_mfma_f32_16x16x32_bf16 v[68:71], v[116:119], v[156:159], v[68:71]
    v_mfma_f32_16x16x32_bf16 v[72:75], v[120:123], v[156:159], v[72:75]
    v_mfma_f32_16x16x32_bf16 v[76:79], v[124:127], v[156:159], v[76:79]
    v_mfma_f32_16x16x32_bf16 v[80:83], v[128:131], v[156:159], v[80:83]
    v_mfma_f32_16x16x32_bf16 v[84:87], v[132:135], v[156:159], v[84:87]
L_cs_34:
    s_waitcnt lgkmcnt(0)
    v_mfma_f32_16x16x32_bf16 v[236:239], v[156:159], v[136:139], v[236:239]
    v_mfma_f32_16x16x32_bf16 v[244:247], v[136:139], v[136:139], v[244:247]
    v_mfma_f32_16x16x32_bf16 v[240:243], v[156:159], v[140:143], v[240:243]
    v_mfma_f32_16x16x32_bf16 v[248:251], v[140:143], v[140:143], v[248:251]
    v_mfma_f32_16x16x32_bf16 v[16:19], v[88:91], v[136:139], v[16:19]
    ds_read_b128 v[144:147], v165 offset:0
    ds_read_b128 v[148:151], v165 offset:2048
    ds_read_b64_tr_b16 v[112:113], v166 offset:6144
    v_mfma_f32_16x16x32_bf16 v[40:43], v[88:91], v[140:143], v[40:43]
    ds_read_b64_tr_b16 v[114:115], v166 offset:6912
    ds_read_b64_tr_b16 v[116:117], v167 offset:6176
    ds_read_b64_tr_b16 v[118:119], v167 offset:6944
    v_mfma_f32_16x16x32_bf16 v[20:23], v[92:95], v[136:139], v[20:23]
    ds_read_b64_tr_b16 v[120:121], v166 offset:6208
    ds_read_b64_tr_b16 v[122:123], v166 offset:6976
    ds_read_b64_tr_b16 v[124:125], v167 offset:6240
    v_mfma_f32_16x16x32_bf16 v[44:47], v[92:95], v[140:143], v[44:47]
    ds_read_b64_tr_b16 v[126:127], v167 offset:7008
    ds_read_b64_tr_b16 v[128:129], v166 offset:6272
    ds_read_b64_tr_b16 v[130:131], v166 offset:7040
    v_mfma_f32_16x16x32_bf16 v[24:27], v[96:99], v[136:139], v[24:27]
    ds_read_b64_tr_b16 v[132:133], v167 offset:6304
    ds_read_b64_tr_b16 v[134:135], v167 offset:7072
    v_mfma_f32_16x16x32_bf16 v[48:51], v[96:99], v[140:143], v[48:51]
    v_mfma_f32_16x16x32_bf16 v[28:31], v[100:103], v[136:139], v[28:31]
    v_mfma_f32_16x16x32_bf16 v[52:55], v[100:103], v[140:143], v[52:55]
    v_mfma_f32_16x16x32_bf16 v[32:35], v[104:107], v[136:139], v[32:35]
    v_mfma_f32_16x16x32_bf16 v[56:59], v[104:107], v[140:143], v[56:59]
    v_mfma_f32_16x16x32_bf16 v[36:39], v[108:111], v[136:139], v[36:39]
    v_mfma_f32_16x16x32_bf16 v[60:63], v[108:111], v[140:143], v[60:63]
    s_cmp_lg_u32 s24, 0
    s_cbranch_scc1 L_cs_35
    v_mfma_f32_16x16x32_bf16 v[64:67], v[88:91], v[156:159], v[64:67]
    v_mfma_f32_16x16x32_bf16 v[68:71], v[92:95], v[156:159], v[68:71]
    v_mfma_f32_16x16x32_bf16 v[72:75], v[96:99], v[156:159], v[72:75]
    v_mfma_f32_16x16x32_bf16 v[76:79], v[100:103], v[156:159], v[76:79]
    v_mfma_f32_16x16x32_bf16 v[80:83], v[104:107], v[156:159], v[80:83]
    v_mfma_f32_16x16x32_bf16 v[84:87], v[108:111], v[156:159], v[84:87]
L_cs_35:
    s_waitcnt lgkmcnt(0)
    s_waitcnt vmcnt(0)
    v_mov_b32 v234, 10
    s_mov_b64 exec, 1
    ds_write_b32 v232, v234
    s_mov_b64 exec, -1
    v_mfma_f32_16x16x32_bf16 v[236:239], v[156:159], v[144:147], v[236:239]
    v_mfma_f32_16x16x32_bf16 v[244:247], v[144:147], v[144:147], v[244:247]
    v_mfma_f32_16x16x32_bf16 v[240:243], v[156:159], v[148:151], v[240:243]
    ds_read_b128 v[228:231], v233
    v_mfma_f32_16x16x32_bf16 v[248:251], v[148:151], v[148:151], v[248:251]
    s_waitcnt lgkmcnt(0)
    v_min3_u32 v228, v228, v229, v230
    v_min_u32 v228, v228, v231
    v_cmp_gt_u32 vcc, 10, v228
    s_nop 1
    s_cbranch_vccz L_sd_37
L_sy_36:
    ds_read_b128 v[228:231], v233
    s_waitcnt lgkmcnt(0)
    v_min3_u32 v228, v228, v229, v230
    v_min_u32 v228, v228, v231
    v_cmp_gt_u32 vcc, 10, v228
    s_nop 1
    s_cbranch_vccnz L_sy_36
L_sd_37:
    v_mfma_f32_16x16x32_bf16 v[16:19], v[112:115], v[144:147], v[16:19]
    ds_read_b128 v[136:139], v164 offset:16384
    ds_read_b128 v[140:143], v164 offset:18432
    ds_read_b64_tr_b16 v[88:89], v166 offset:12288
    v_mfma_f32_16x16x32_bf16 v[40:43], v[112:115], v[148:151], v[40:43]
    ds_read_b64_tr_b16 v[90:91], v166 offset:13056
    ds_read_b64_tr_b16 v[92:93], v167 offset:12320
    ds_read_b64_tr_b16 v[94:95], v167 offset:13088
    v_mfma_f32_16x16x32_bf16 v[20:23], v[116:119], v[144:147], v[20:23]
    ds_read_b64_tr_b16 v[96:97], v166 offset:12352
    ds_read_b64_tr_b16 v[98:99], v166 offset:13120
    ds_read_b64_tr_b16 v[100:101], v167 offset:12384
    v_mfma_f32_16x16x32_bf16 v[44:47], v[116:119], v[148:151], v[44:47]
    ds_read_b64_tr_b16 v[102:103], v167 offset:13152
    ds_read_b64_tr_b16 v[104:105], v166 offset:12416
    ds_read_b64_tr_b16 v[106:107], v166 offset:13184
    v_mfma_f32_16x16x32_bf16 v[24:27], v[120:123], v[144:147], v[24:27]
    ds_read_b64_tr_b16 v[108:109], v167 offset:12448
    ds_read_b64_tr_b16 v[110:111], v167 offset:13216
    v_mfma_f32_16x16x32_bf16 v[48:51], v[120:123], v[148:151], v[48:51]
    v_mfma_f32_16x16x32_bf16 v[28:31], v[124:127], v[144:147], v[28:31]
    v_mfma_f32_16x16x32_bf16 v[52:55], v[124:127], v[148:151], v[52:55]
    v_mfma_f32_16x16x32_bf16 v[32:35], v[128:131], v[144:147], v[32:35]
    v_mfma_f32_16x16x32_bf16 v[56:59], v[128:131], v[148:151], v[56:59]
    v_mfma_f32_16x16x32_bf16 v[36:39], v[132:135], v[144:147], v[36:39]
    v_mfma_f32_16x16x32_bf16 v[60:63], v[132:135], v[148:151], v[60:63]
    s_cmp_lg_u32 s24, 1
    s_cbranch_scc1 L_cs_38
    v_mfma_f32_16x16x32_bf16 v[64:67], v[112:115], v[156:159], v[64:67]
    v_mfma_f32_16x16x32_bf16 v[68:71], v[116:119], v[156:159], v[68:71]
    v_mfma_f32_16x16x32_bf16 v[72:75], v[120:123], v[156:159], v[72:75]
    v_mfma_f32_16x16x32_bf16 v[76:79], v[124:127], v[156:159], v[76:79]
    v_mfma_f32_16x16x32_bf16 v[80:83], v[128:131], v[156:159], v[80:83]
    v_mfma_f32_16x16x32_bf16 v[84:87], v[132:135], v[156:159], v[84:87]
L_cs_38:
    s_waitcnt lgkmcnt(0)
    v_mfma_f32_16x16x32_bf16 v[236:239], v[156:159], v[136:139], v[236:239]
    v_mfma_f32_16x16x32_bf16 v[244:247], v[136:139], v[136:139], v[244:247]
    v_mfma_f32_16x16x32_bf16 v[240:243], v[156:159], v[140:143], v[240:243]
    v_mfma_f32_16x16x32_bf16 v[248:251], v[140:143], v[140:143], v[248:251]
    v_mfma_f32_16x16x32_bf16 v[16:19], v[88:91], v[136:139], v[16:19]
    ds_read_b128 v[144:147], v165 offset:16384
    ds_read_b128 v[148:151], v165 offset:18432
    ds_read_b64_tr_b16 v[112:113], v166 offset:18432
    v_mfma_f32_16x16x32_bf16 v[40:43], v[88:91], v[140:143], v[40:43]
    ds_read_b64_tr_b16 v[114:115], v166 offset:19200
    ds_read_b64_tr_b16 v[116:117], v167 offset:18464
    ds_read_b64_tr_b16 v[118:119], v167 offset:19232
    v_mfma_f32_16x16x32_bf16 v[20:23], v[92:95], v[136:139], v[20:23]
    ds_read_b64_tr_b16 v[120:121], v166 offset:18496
    ds_read_b64_tr_b16 v[122:123], v166 offset:19264
    ds_read_b64_tr_b16 v[124:125], v167 offset:18528
    v_mfma_f32_16x16x32_bf16 v[44:47], v[92:95], v[140:143], v[44:47]
    ds_read_b64_tr_b16 v[126:127], v167 offset:19296
    ds_read_b64_tr_b16 v[128:129], v166 offset:18560
    ds_read_b64_tr_b16 v[130:131], v166 offset:19328
    v_mfma_f32_16x16x32_bf16 v[24:27], v[96:99], v[136:139], v[24:27]
    ds_read_b64_tr_b16 v[132:133], v167 offset:18592
    ds_read_b64_tr_b16 v[134:135], v167 offset:19360
    v_mfma_f32_16x16x32_bf16 v[48:51], v[96:99], v[140:143], v[48:51]
    v_mfma_f32_16x16x32_bf16 v[28:31], v[100:103], v[136:139], v[28:31]
    v_mfma_f32_16x16x32_bf16 v[52:55], v[100:103], v[140:143], v[52:55]
    v_mfma_f32_16x16x32_bf16 v[32:35], v[104:107], v[136:139], v[32:35]
    v_mfma_f32_16x16x32_bf16 v[56:59], v[104:107], v[140:143], v[56:59]
    v_mfma_f32_16x16x32_bf16 v[36:39], v[108:111], v[136:139], v[36:39]
    v_mfma_f32_16x16x32_bf16 v[60:63], v[108:111], v[140:143], v[60:63]
    s_cmp_lg_u32 s24, 2
    s_cbranch_scc1 L_cs_39
    v_mfma_f32_16x16x32_bf16 v[64:67], v[88:91], v[156:159], v[64:67]
    v_mfma_f32_16x16x32_bf16 v[68:71], v[92:95], v[156:159], v[68:71]
    v_mfma_f32_16x16x32_bf16 v[72:75], v[96:99], v[156:159], v[72:75]
    v_mfma_f32_16x16x32_bf16 v[76:79], v[100:103], v[156:159], v[76:79]
    v_mfma_f32_16x16x32_bf16 v[80:83], v[104:107], v[156:159], v[80:83]
    v_mfma_f32_16x16x32_bf16 v[84:87], v[108:111], v[156:159], v[84:87]
L_cs_39:
    s_waitcnt lgkmcnt(0)
    v_mfma_f32_16x16x32_bf16 v[236:239], v[156:159], v[144:147], v[236:239]
    v_mfma_f32_16x16x32_bf16 v[244:247], v[144:147], v[144:147], v[244:247]
    v_mfma_f32_16x16x32_bf16 v[240:243], v[156:159], v[148:151], v[240:243]
    v_mfma_f32_16x16x32_bf16 v[248:251], v[148:151], v[148:151], v[248:251]
    v_mfma_f32_16x16x32_bf16 v[16:19], v[112:115], v[144:147], v[16:19]
    v_mfma_f32_16x16x32_bf16 v[40:43], v[112:115], v[148:151], v[40:43]
    v_mfma_f32_16x16x32_bf16 v[20:23], v[116:119], v[144:147], v[20:23]
    v_mfma_f32_16x16x32_bf16 v[44:47], v[116:119], v[148:151], v[44:47]
    v_mfma_f32_16x16x32_bf16 v[24:27], v[120:123], v[144:147], v[24:27]
    v_mfma_f32_16x16x32_bf16 v[48:51], v[120:123], v[148:151], v[48:51]
    v_mfma_f32_16x16x32_bf16 v[28:31], v[124:127], v[144:147], v[28:31]
    v_mfma_f32_16x16x32_bf16 v[52:55], v[124:127], v[148:151], v[52:55]
    v_mfma_f32_16x16x32_bf16 v[32:35], v[128:131], v[144:147], v[32:35]
    v_mfma_f32_16x16x32_bf16 v[56:59], v[128:131], v[148:151], v[56:59]
    v_mfma_f32_16x16x32_bf16 v[36:39], v[132:135], v[144:147], v[36:39]
    v_mfma_f32_16x16x32_bf16 v[60:63], v[132:135], v[148:151], v[60:63]
    s_cmp_lg_u32 s24, 3
    s_cbranch_scc1 L_cs_40
    v_mfma_f32_16x16x32_bf16 v[64:67], v[112:115], v[156:159], v[64:67]
    v_mfma_f32_16x16x32_bf16 v[68:71], v[116:119], v[156:159], v[68:71]
    v_mfma_f32_16x16x32_bf16 v[72:75], v[120:123], v[156:159], v[72:75]
    v_mfma_f32_16x16x32_bf16 v[76:79], v[124:127], v[156:159], v[76:79]
    v_mfma_f32_16x16x32_bf16 v[80:83], v[128:131], v[156:159], v[80:83]
    v_mfma_f32_16x16x32_bf16 v[84:87], v[132:135], v[156:159], v[84:87]
L_cs_40:
    s_nop 7
    v_lshlrev_b32 v180, 4, v3
    v_add_u32 v180, 114688, v180
    v_cmp_eq_u32 vcc, 0, v2
    s_nop 1
    s_and_saveexec_b64 s[42:43], vcc
    ds_add_f32 v180, v64 offset:0
    ds_add_f32 v180, v65 offset:4
    ds_add_f32 v180, v66 offset:8
    ds_add_f32 v180, v67 offset:12
    ds_add_f32 v180, v68 offset:64
    ds_add_f32 v180, v69 offset:68
    ds_add_f32 v180, v70 offset:72
    ds_add_f32 v180, v71 offset:76
    ds_add_f32 v180, v72 offset:128
    ds_add_f32 v180, v73 offset:132
    ds_add_f32 v180, v74 offset:136
    ds_add_f32 v180, v75 offset:140
    ds_add_f32 v180, v76 offset:192
    ds_add_f32 v180, v77 offset:196
    ds_add_f32 v180, v78 offset:200
    ds_add_f32 v180, v79 offset:204
    ds_add_f32 v180, v80 offset:256
    ds_add_f32 v180, v81 offset:260
    ds_add_f32 v180, v82 offset:264
    ds_add_f32 v180, v83 offset:268
    ds_add_f32 v180, v84 offset:320
    ds_add_f32 v180, v85 offset:324
    ds_add_f32 v180, v86 offset:328
    ds_add_f32 v180, v87 offset:332
    s_mov_b64 exec, -1
    v_and_b32 v188, 3, v2
    v_lshrrev_b32 v189, 2, v2
    v_mov_b32 v152, v236
    v_mov_b32 v154, v244
    v_cmp_eq_u32 vcc, 1, v188
    s_nop 1
    v_cndmask_b32 v154, v154, v245, vcc
    v_cmp_eq_u32 vcc, 2, v188
    s_nop 1
    v_cndmask_b32 v154, v154, v246, vcc
    v_cmp_eq_u32 vcc, 3, v188
    s_nop 1
    v_cndmask_b32 v154, v154, v247, vcc
    v_cmp_eq_u32 vcc, v189, v3
    s_nop 1
    v_cndmask_b32 v154, 0, v154, vcc
    v_mov_b32 v153, v240
    v_mov_b32 v155, v248
    v_cmp_eq_u32 vcc, 1, v188
    s_nop 1
    v_cndmask_b32 v155, v155, v249, vcc
    v_cmp_eq_u32 vcc, 2, v188
    s_nop 1
    v_cndmask_b32 v155, v155, v250, vcc
    v_cmp_eq_u32 vcc, 3, v188
    s_nop 1
    v_cndmask_b32 v155, v155, v251, vcc
    v_cmp_eq_u32 vcc, v189, v3
    s_nop 1
    v_cndmask_b32 v155, 0, v155, vcc
    v_mov_b32 v188, v154
    s_nop 1
    v_permlane16_swap_b32 v154, v188
    s_nop 1
    v_add_f32 v154, v154, v188
    v_mov_b32 v188, v154
    s_nop 1
    v_permlane32_swap_b32 v154, v188
    s_nop 1
    v_add_f32 v154, v154, v188
    v_mov_b32 v188, v155
    s_nop 1
    v_permlane16_swap_b32 v155, v188
    s_nop 1
    v_add_f32 v155, v155, v188
    v_mov_b32 v188, v155
    s_nop 1
    v_permlane32_swap_b32 v155, v188
    s_nop 1
    v_add_f32 v155, v155, v188
    s_mov_b32 s44, 0x3acccccd
    s_mov_b32 s45, 0x3727c5ac
    v_mul_f32 v152, s44, v152
    v_mul_f32 v154, s44, v154
    v_fma_f32 v154, -v152, v152, v154
    v_max_f32 v154, 0, v154
    v_cvt_pk_bf16_f32 v152, v152, v152
    v_cvt_pk_bf16_f32 v154, v154, v154
    v_lshlrev_b32 v152, 16, v152
    v_lshlrev_b32 v154, 16, v154
    v_add_f32 v154, s45, v154
    v_cvt_pk_bf16_f32 v154, v154, v154
    v_lshlrev_b32 v154, 16, v154
    v_sqrt_f32 v154, v154
    s_nop 0
    v_cvt_pk_bf16_f32 v154, v154, v154
    v_lshlrev_b32 v154, 16, v154
    v_rcp_f32 v194, v154
    v_sub_f32 v190, 0, v152
    v_mul_f32 v153, s44, v153
    v_mul_f32 v155, s44, v155
    v_fma_f32 v155, -v153, v153, v155
    v_max_f32 v155, 0, v155
    v_cvt_pk_bf16_f32 v153, v153, v153
    v_cvt_pk_bf16_f32 v155, v155, v155
    v_lshlrev_b32 v153, 16, v153
    v_lshlrev_b32 v155, 16, v155
    v_add_f32 v155, s45, v155
    v_cvt_pk_bf16_f32 v155, v155, v155
    v_lshlrev_b32 v155, 16, v155
    v_sqrt_f32 v155, v155
    s_nop 0
    v_cvt_pk_bf16_f32 v155, v155, v155
    v_lshlrev_b32 v155, 16, v155
    v_rcp_f32 v196, v155
    v_sub_f32 v192, 0, v153
    s_cmp_lg_u32 s26, 0
    s_cbranch_scc1 A_nostat
    v_add_u32 v188, s39, v2
    v_lshlrev_b32 v188, 3, v188
    v_add_u32 v188, 13500416, v188
    v_cmp_gt_u32 vcc, 16, v1
    s_nop 1
    s_and_saveexec_b64 s[42:43], vcc
    v_mov_b32 v198, v152
    v_mov_b32 v199, v194
    buffer_store_dwordx2 v[198:199], v188, s[16:19], 0 offen offset:0 sc1
    s_nop 1
    v_mov_b32 v198, v153
    v_mov_b32 v199, v196
    buffer_store_dwordx2 v[198:199], v188, s[16:19], 0 offen offset:128 sc1
    s_nop 1
    s_mov_b64 exec, -1
A_nostat:
    s_waitcnt lgkmcnt(0)
    v_mov_b32 v234, 12
    s_mov_b64 exec, 1
    ds_write_b32 v232, v234
    s_mov_b64 exec, -1
L_sy_41:
    ds_read_b128 v[228:231], v233
    s_waitcnt lgkmcnt(0)
    v_min3_u32 v228, v228, v229, v230
    v_min_u32 v228, v228, v231
    v_cmp_gt_u32 vcc, 12, v228
    s_nop 1
    s_cbranch_vccnz L_sy_41
    v_lshlrev_b32 v180, 4, v3
    v_add_u32 v180, 114688, v180
    ds_read_b128 v[88:91], v180 offset:0
    ds_read_b128 v[92:95], v180 offset:64
    ds_read_b128 v[96:99], v180 offset:128
    ds_read_b128 v[100:103], v180 offset:192
    ds_read_b128 v[104:107], v180 offset:256
    ds_read_b128 v[108:111], v180 offset:320
    v_lshlrev_b32 v112, 16, v168
    v_and_b32 v113, 0xffff0000, v168
    v_lshlrev_b32 v114, 16, v169
    v_and_b32 v115, 0xffff0000, v169
    v_lshlrev_b32 v116, 16, v170
    v_and_b32 v117, 0xffff0000, v170
    v_lshlrev_b32 v118, 16, v171
    v_and_b32 v119, 0xffff0000, v171
    v_lshlrev_b32 v120, 16, v172
    v_and_b32 v121, 0xffff0000, v172
    v_lshlrev_b32 v122, 16, v173
    v_and_b32 v123, 0xffff0000, v173
    v_lshlrev_b32 v124, 16, v174
    v_and_b32 v125, 0xffff0000, v174
    v_lshlrev_b32 v126, 16, v175
    v_and_b32 v127, 0xffff0000, v175
    v_lshlrev_b32 v128, 16, v176
    v_and_b32 v129, 0xffff0000, v176
    v_lshlrev_b32 v130, 16, v177
    v_and_b32 v131, 0xffff0000, v177
    v_lshlrev_b32 v132, 16, v178
    v_and_b32 v133, 0xffff0000, v178
    v_lshlrev_b32 v134, 16, v179
    v_and_b32 v135, 0xffff0000, v179
    s_mov_b32 s46, 0xbdd2d3e8
    s_mov_b32 s47, 0xbdd2d3e8
    v_mov_b32 v200, 0xc0135761
    v_mov_b32 v201, 0xc0135761
    v_mov_b32 v202, 1.0
    v_mov_b32 v203, 1.0
    s_lshl_b32 s48, s25, 3
    s_lshl_b32 s49, s24, 1
    s_add_u32 s48, s48, s49
    s_mul_i32 s48, s48, 48
    s_mul_i32 s49, s26, 3
    s_add_u32 s48, s48, s49
    s_lshl_b32 s48, s48, 10
    s_add_u32 s49, s48, 49152
    v_lshlrev_b32 v181, 4, v1
    s_waitcnt lgkmcnt(0)
    v_fma_f32 v204, v88, v190, v16
    v_fma_f32 v205, v89, v190, v17
    v_fma_f32 v206, v90, v190, v18
    v_fma_f32 v207, v91, v190, v19
    v_fma_f32 v204, v204, v194, v112
    v_fma_f32 v205, v205, v194, v113
    v_fma_f32 v206, v206, v194, v114
    v_fma_f32 v207, v207, v194, v115
    v_mul_f32 v212, v204, v204
    v_mul_f32 v213, v205, v205
    v_mul_f32 v214, v206, v206
    v_mul_f32 v215, v207, v207
    v_fma_f32 v212, v212, s46, v200
    v_fma_f32 v213, v213, s46, v200
    v_fma_f32 v214, v214, s46, v200
    v_fma_f32 v215, v215, s46, v200
    v_mul_f32 v212, v212, v204
    v_mul_f32 v213, v213, v205
    v_mul_f32 v214, v214, v206
    v_mul_f32 v215, v215, v207
    v_exp_f32 v212, v212
    v_exp_f32 v213, v213
    v_exp_f32 v214, v214
    v_exp_f32 v215, v215
    v_add_f32 v212, 1.0, v212
    v_add_f32 v213, 1.0, v213
    v_add_f32 v214, 1.0, v214
    v_add_f32 v215, 1.0, v215
    v_rcp_f32 v212, v212
    v_rcp_f32 v213, v213
    v_rcp_f32 v214, v214
    v_rcp_f32 v215, v215
    v_mul_f32 v204, v204, v212
    v_mul_f32 v205, v205, v213
    v_mul_f32 v206, v206, v214
    v_mul_f32 v207, v207, v215
    v_cvt_pk_bf16_f32 v220, v204, v205
    v_cvt_pk_bf16_f32 v221, v206, v207
    v_fma_f32 v208, v92, v190, v20
    v_fma_f32 v209, v93, v190, v21
    v_fma_f32 v210, v94, v190, v22
    v_fma_f32 v211, v95, v190, v23
    v_fma_f32 v208, v208, v194, v116
    v_fma_f32 v209, v209, v194, v117
    v_fma_f32 v210, v210, v194, v118
    v_fma_f32 v211, v211, v194, v119
    v_mul_f32 v216, v208, v208
    v_mul_f32 v217, v209, v209
    v_mul_f32 v218, v210, v210
    v_mul_f32 v219, v211, v211
    v_fma_f32 v216, v216, s46, v200
    v_fma_f32 v217, v217, s46, v200
    v_fma_f32 v218, v218, s46, v200
    v_fma_f32 v219, v219, s46, v200
    v_mul_f32 v216, v216, v208
    v_mul_f32 v217, v217, v209
    v_mul_f32 v218, v218, v210
    v_mul_f32 v219, v219, v211
    v_exp_f32 v216, v216
    v_exp_f32 v217, v217
    v_exp_f32 v218, v218
    v_exp_f32 v219, v219
    v_add_f32 v216, 1.0, v216
    v_add_f32 v217, 1.0, v217
    v_add_f32 v218, 1.0, v218
    v_add_f32 v219, 1.0, v219
    v_rcp_f32 v216, v216
    v_rcp_f32 v217, v217
    v_rcp_f32 v218, v218
    v_rcp_f32 v219, v219
    v_mul_f32 v208, v208, v216
    v_mul_f32 v209, v209, v217
    v_mul_f32 v210, v210, v218
    v_mul_f32 v211, v211, v219
    v_cvt_pk_bf16_f32 v222, v208, v209
    v_cvt_pk_bf16_f32 v223, v210, v211
    buffer_store_dwordx4 v[220:223], v181, s[16:19], s48 offen offset:0 sc1
    v_fma_f32 v204, v96, v190, v24
    v_fma_f32 v205, v97, v190, v25
    v_fma_f32 v206, v98, v190, v26
    v_fma_f32 v207, v99, v190, v27
    v_fma_f32 v204, v204, v194, v120
    v_fma_f32 v205, v205, v194, v121
    v_fma_f32 v206, v206, v194, v122
    v_fma_f32 v207, v207, v194, v123
    v_mul_f32 v212, v204, v204
    v_mul_f32 v213, v205, v205
    v_mul_f32 v214, v206, v206
    v_mul_f32 v215, v207, v207
    v_fma_f32 v212, v212, s46, v200
    v_fma_f32 v213, v213, s46, v200
    v_fma_f32 v214, v214, s46, v200
    v_fma_f32 v215, v215, s46, v200
    v_mul_f32 v212, v212, v204
    v_mul_f32 v213, v213, v205
    v_mul_f32 v214, v214, v206
    v_mul_f32 v215, v215, v207
    v_exp_f32 v212, v212
    v_exp_f32 v213, v213
    v_exp_f32 v214, v214
    v_exp_f32 v215, v215
    v_add_f32 v212, 1.0, v212
    v_add_f32 v213, 1.0, v213
    v_add_f32 v214, 1.0, v214
    v_add_f32 v215, 1.0, v215
    v_rcp_f32 v212, v212
    v_rcp_f32 v213, v213
    v_rcp_f32 v214, v214
    v_rcp_f32 v215, v215
    v_mul_f32 v204, v204, v212
    v_mul_f32 v205, v205, v213
    v_mul_f32 v206, v206, v214
    v_mul_f32 v207, v207, v215
    v_cvt_pk_bf16_f32 v224, v204, v205
    v_cvt_pk_bf16_f32 v225, v206, v207
    v_fma_f32 v208, v100, v190, v28
    v_fma_f32 v209, v101, v190, v29
    v_fma_f32 v210, v102, v190, v30
    v_fma_f32 v211, v103, v190, v31
    v_fma_f32 v208, v208, v194, v124
    v_fma_f32 v209, v209, v194, v125
    v_fma_f32 v210, v210, v194, v126
    v_fma_f32 v211, v211, v194, v127
    v_mul_f32 v216, v208, v208
    v_mul_f32 v217, v209, v209
    v_mul_f32 v218, v210, v210
    v_mul_f32 v219, v211, v211
    v_fma_f32 v216, v216, s46, v200
    v_fma_f32 v217, v217, s46, v200
    v_fma_f32 v218, v218, s46, v200
    v_fma_f32 v219, v219, s46, v200
    v_mul_f32 v216, v216, v208
    v_mul_f32 v217, v217, v209
    v_mul_f32 v218, v218, v210
    v_mul_f32 v219, v219, v211
    v_exp_f32 v216, v216
    v_exp_f32 v217, v217
    v_exp_f32 v218, v218
    v_exp_f32 v219, v219
    v_add_f32 v216, 1.0, v216
    v_add_f32 v217, 1.0, v217
    v_add_f32 v218, 1.0, v218
    v_add_f32 v219, 1.0, v219
    v_rcp_f32 v216, v216
    v_rcp_f32 v217, v217
    v_rcp_f32 v218, v218
    v_rcp_f32 v219, v219
    v_mul_f32 v208, v208, v216
    v_mul_f32 v209, v209, v217
    v_mul_f32 v210, v210, v218
    v_mul_f32 v211, v211, v219
    v_cvt_pk_bf16_f32 v226, v208, v209
    v_cvt_pk_bf16_f32 v227, v210, v211
    buffer_store_dwordx4 v[224:227], v181, s[16:19], s48 offen offset:1024 sc1
    v_fma_f32 v204, v104, v190, v32
    v_fma_f32 v205, v105, v190, v33
    v_fma_f32 v206, v106, v190, v34
    v_fma_f32 v207, v107, v190, v35
    v_fma_f32 v204, v204, v194, v128
    v_fma_f32 v205, v205, v194, v129
    v_fma_f32 v206, v206, v194, v130
    v_fma_f32 v207, v207, v194, v131
    v_mul_f32 v212, v204, v204
    v_mul_f32 v213, v205, v205
    v_mul_f32 v214, v206, v206
    v_mul_f32 v215, v207, v207
    v_fma_f32 v212, v212, s46, v200
    v_fma_f32 v213, v213, s46, v200
    v_fma_f32 v214, v214, s46, v200
    v_fma_f32 v215, v215, s46, v200
    v_mul_f32 v212, v212, v204
    v_mul_f32 v213, v213, v205
    v_mul_f32 v214, v214, v206
    v_mul_f32 v215, v215, v207
    v_exp_f32 v212, v212
    v_exp_f32 v213, v213
    v_exp_f32 v214, v214
    v_exp_f32 v215, v215
    v_add_f32 v212, 1.0, v212
    v_add_f32 v213, 1.0, v213
    v_add_f32 v214, 1.0, v214
    v_add_f32 v215, 1.0, v215
    v_rcp_f32 v212, v212
    v_rcp_f32 v213, v213
    v_rcp_f32 v214, v214
    v_rcp_f32 v215, v215
    v_mul_f32 v204, v204, v212
    v_mul_f32 v205, v205, v213
    v_mul_f32 v206, v206, v214
    v_mul_f32 v207, v207, v215
    v_cvt_pk_bf16_f32 v228, v204, v205
    v_cvt_pk_bf16_f32 v229, v206, v207
    v_fma_f32 v208, v108, v190, v36
    v_fma_f32 v209, v109, v190, v37
    v_fma_f32 v210, v110, v190, v38
    v_fma_f32 v211, v111, v190, v39
    v_fma_f32 v208, v208, v194, v132
    v_fma_f32 v209, v209, v194, v133
    v_fma_f32 v210, v210, v194, v134
    v_fma_f32 v211, v211, v194, v135
    v_mul_f32 v216, v208, v208
    v_mul_f32 v217, v209, v209
    v_mul_f32 v218, v210, v210
    v_mul_f32 v219, v211, v211
    v_fma_f32 v216, v216, s46, v200
    v_fma_f32 v217, v217, s46, v200
    v_fma_f32 v218, v218, s46, v200
    v_fma_f32 v219, v219, s46, v200
    v_mul_f32 v216, v216, v208
    v_mul_f32 v217, v217, v209
    v_mul_f32 v218, v218, v210
    v_mul_f32 v219, v219, v211
    v_exp_f32 v216, v216
    v_exp_f32 v217, v217
    v_exp_f32 v218, v218
    v_exp_f32 v219, v219
    v_add_f32 v216, 1.0, v216
    v_add_f32 v217, 1.0, v217
    v_add_f32 v218, 1.0, v218
    v_add_f32 v219, 1.0, v219
    v_rcp_f32 v216, v216
    v_rcp_f32 v217, v217
    v_rcp_f32 v218, v218
    v_rcp_f32 v219, v219
    v_mul_f32 v208, v208, v216
    v_mul_f32 v209, v209, v217
    v_mul_f32 v210, v210, v218
    v_mul_f32 v211, v211, v219
    v_cvt_pk_bf16_f32 v230, v208, v209
    v_cvt_pk_bf16_f32 v231, v210, v211
    buffer_store_dwordx4 v[228:231], v181, s[16:19], s48 offen offset:2048 sc1
    v_fma_f32 v204, v88, v192, v40
    v_fma_f32 v205, v89, v192, v41
    v_fma_f32 v206, v90, v192, v42
    v_fma_f32 v207, v91, v192, v43
    v_fma_f32 v204, v204, v196, v112
    v_fma_f32 v205, v205, v196, v113
    v_fma_f32 v206, v206, v196, v114
    v_fma_f32 v207, v207, v196, v115
    v_mul_f32 v212, v204, v204
    v_mul_f32 v213, v205, v205
    v_mul_f32 v214, v206, v206
    v_mul_f32 v215, v207, v207
    v_fma_f32 v212, v212, s46, v200
    v_fma_f32 v213, v213, s46, v200
    v_fma_f32 v214, v214, s46, v200
    v_fma_f32 v215, v215, s46, v200
    v_mul_f32 v212, v212, v204
    v_mul_f32 v213, v213, v205
    v_mul_f32 v214, v214, v206
    v_mul_f32 v215, v215, v207
    v_exp_f32 v212, v212
    v_exp_f32 v213, v213
    v_exp_f32 v214, v214
    v_exp_f32 v215, v215
    v_add_f32 v212, 1.0, v212
    v_add_f32 v213, 1.0, v213
    v_add_f32 v214, 1.0, v214
    v_add_f32 v215, 1.0, v215
    v_rcp_f32 v212, v212
    v_rcp_f32 v213, v213
    v_rcp_f32 v214, v214
    v_rcp_f32 v215, v215
    v_mul_f32 v204, v204, v212
    v_mul_f32 v205, v205, v213
    v_mul_f32 v206, v206, v214
    v_mul_f32 v207, v207, v215
    v_cvt_pk_bf16_f32 v232, v204, v205
    v_cvt_pk_bf16_f32 v233, v206, v207
    v_fma_f32 v208, v92, v192, v44
    v_fma_f32 v209, v93, v192, v45
    v_fma_f32 v210, v94, v192, v46
    v_fma_f32 v211, v95, v192, v47
    v_fma_f32 v208, v208, v196, v116
    v_fma_f32 v209, v209, v196, v117
    v_fma_f32 v210, v210, v196, v118
    v_fma_f32 v211, v211, v196, v119
    v_mul_f32 v216, v208, v208
    v_mul_f32 v217, v209, v209
    v_mul_f32 v218, v210, v210
    v_mul_f32 v219, v211, v211
    v_fma_f32 v216, v216, s46, v200
    v_fma_f32 v217, v217, s46, v200
    v_fma_f32 v218, v218, s46, v200
    v_fma_f32 v219, v219, s46, v200
    v_mul_f32 v216, v216, v208
    v_mul_f32 v217, v217, v209
    v_mul_f32 v218, v218, v210
    v_mul_f32 v219, v219, v211
    v_exp_f32 v216, v216
    v_exp_f32 v217, v217
    v_exp_f32 v218, v218
    v_exp_f32 v219, v219
    v_add_f32 v216, 1.0, v216
    v_add_f32 v217, 1.0, v217
    v_add_f32 v218, 1.0, v218
    v_add_f32 v219, 1.0, v219
    v_rcp_f32 v216, v216
    v_rcp_f32 v217, v217
    v_rcp_f32 v218, v218
    v_rcp_f32 v219, v219
    v_mul_f32 v208, v208, v216
    v_mul_f32 v209, v209, v217
    v_mul_f32 v210, v210, v218
    v_mul_f32 v211, v211, v219
    v_cvt_pk_bf16_f32 v234, v208, v209
    v_cvt_pk_bf16_f32 v235, v210, v211
    buffer_store_dwordx4 v[232:235], v181, s[16:19], s49 offen offset:0 sc1
    v_fma_f32 v204, v96, v192, v48
    v_fma_f32 v205, v97, v192, v49
    v_fma_f32 v206, v98, v192, v50
    v_fma_f32 v207, v99, v192, v51
    v_fma_f32 v204, v204, v196, v120
    v_fma_f32 v205, v205, v196, v121
    v_fma_f32 v206, v206, v196, v122
    v_fma_f32 v207, v207, v196, v123
    v_mul_f32 v212, v204, v204
    v_mul_f32 v213, v205, v205
    v_mul_f32 v214, v206, v206
    v_mul_f32 v215, v207, v207
    v_fma_f32 v212, v212, s46, v200
    v_fma_f32 v213, v213, s46, v200
    v_fma_f32 v214, v214, s46, v200
    v_fma_f32 v215, v215, s46, v200
    v_mul_f32 v212, v212, v204
    v_mul_f32 v213, v213, v205
    v_mul_f32 v214, v214, v206
    v_mul_f32 v215, v215, v207
    v_exp_f32 v212, v212
    v_exp_f32 v213, v213
    v_exp_f32 v214, v214
    v_exp_f32 v215, v215
    v_add_f32 v212, 1.0, v212
    v_add_f32 v213, 1.0, v213
    v_add_f32 v214, 1.0, v214
    v_add_f32 v215, 1.0, v215
    v_rcp_f32 v212, v212
    v_rcp_f32 v213, v213
    v_rcp_f32 v214, v214
    v_rcp_f32 v215, v215
    v_mul_f32 v204, v204, v212
    v_mul_f32 v205, v205, v213
    v_mul_f32 v206, v206, v214
    v_mul_f32 v207, v207, v215
    v_cvt_pk_bf16_f32 v220, v204, v205
    v_cvt_pk_bf16_f32 v221, v206, v207
    v_fma_f32 v208, v100, v192, v52
    v_fma_f32 v209, v101, v192, v53
    v_fma_f32 v210, v102, v192, v54
    v_fma_f32 v211, v103, v192, v55
    v_fma_f32 v208, v208, v196, v124
    v_fma_f32 v209, v209, v196, v125
    v_fma_f32 v210, v210, v196, v126
    v_fma_f32 v211, v211, v196, v127
    v_mul_f32 v216, v208, v208
    v_mul_f32 v217, v209, v209
    v_mul_f32 v218, v210, v210
    v_mul_f32 v219, v211, v211
    v_fma_f32 v216, v216, s46, v200
    v_fma_f32 v217, v217, s46, v200
    v_fma_f32 v218, v218, s46, v200
    v_fma_f32 v219, v219, s46, v200
    v_mul_f32 v216, v216, v208
    v_mul_f32 v217, v217, v209
    v_mul_f32 v218, v218, v210
    v_mul_f32 v219, v219, v211
    v_exp_f32 v216, v216
    v_exp_f32 v217, v217
    v_exp_f32 v218, v218
    v_exp_f32 v219, v219
    v_add_f32 v216, 1.0, v216
    v_add_f32 v217, 1.0, v217
    v_add_f32 v218, 1.0, v218
    v_add_f32 v219, 1.0, v219
    v_rcp_f32 v216, v216
    v_rcp_f32 v217, v217
    v_rcp_f32 v218, v218
    v_rcp_f32 v219, v219
    v_mul_f32 v208, v208, v216
    v_mul_f32 v209, v209, v217
    v_mul_f32 v210, v210, v218
    v_mul_f32 v211, v211, v219
    v_cvt_pk_bf16_f32 v222, v208, v209
    v_cvt_pk_bf16_f32 v223, v210, v211
    buffer_store_dwordx4 v[220:223], v181, s[16:19], s49 offen offset:1024 sc1
    v_fma_f32 v204, v104, v192, v56
    v_fma_f32 v205, v105, v192, v57
    v_fma_f32 v206, v106, v192, v58
    v_fma_f32 v207, v107, v192, v59
    v_fma_f32 v204, v204, v196, v128
    v_fma_f32 v205, v205, v196, v129
    v_fma_f32 v206, v206, v196, v130
    v_fma_f32 v207, v207, v196, v131
    v_mul_f32 v212, v204, v204
    v_mul_f32 v213, v205, v205
    v_mul_f32 v214, v206, v206
    v_mul_f32 v215, v207, v207
    v_fma_f32 v212, v212, s46, v200
    v_fma_f32 v213, v213, s46, v200
    v_fma_f32 v214, v214, s46, v200
    v_fma_f32 v215, v215, s46, v200
    v_mul_f32 v212, v212, v204
    v_mul_f32 v213, v213, v205
    v_mul_f32 v214, v214, v206
    v_mul_f32 v215, v215, v207
    v_exp_f32 v212, v212
    v_exp_f32 v213, v213
    v_exp_f32 v214, v214
    v_exp_f32 v215, v215
    v_add_f32 v212, 1.0, v212
    v_add_f32 v213, 1.0, v213
    v_add_f32 v214, 1.0, v214
    v_add_f32 v215, 1.0, v215
    v_rcp_f32 v212, v212
    v_rcp_f32 v213, v213
    v_rcp_f32 v214, v214
    v_rcp_f32 v215, v215
    v_mul_f32 v204, v204, v212
    v_mul_f32 v205, v205, v213
    v_mul_f32 v206, v206, v214
    v_mul_f32 v207, v207, v215
    v_cvt_pk_bf16_f32 v224, v204, v205
    v_cvt_pk_bf16_f32 v225, v206, v207
    v_fma_f32 v208, v108, v192, v60
    v_fma_f32 v209, v109, v192, v61
    v_fma_f32 v210, v110, v192, v62
    v_fma_f32 v211, v111, v192, v63
    v_fma_f32 v208, v208, v196, v132
    v_fma_f32 v209, v209, v196, v133
    v_fma_f32 v210, v210, v196, v134
    v_fma_f32 v211, v211, v196, v135
    v_mul_f32 v216, v208, v208
    v_mul_f32 v217, v209, v209
    v_mul_f32 v218, v210, v210
    v_mul_f32 v219, v211, v211
    v_fma_f32 v216, v216, s46, v200
    v_fma_f32 v217, v217, s46, v200
    v_fma_f32 v218, v218, s46, v200
    v_fma_f32 v219, v219, s46, v200
    v_mul_f32 v216, v216, v208
    v_mul_f32 v217, v217, v209
    v_mul_f32 v218, v218, v210
    v_mul_f32 v219, v219, v211
    v_exp_f32 v216, v216
    v_exp_f32 v217, v217
    v_exp_f32 v218, v218
    v_exp_f32 v219, v219
    v_add_f32 v216, 1.0, v216
    v_add_f32 v217, 1.0, v217
    v_add_f32 v218, 1.0, v218
    v_add_f32 v219, 1.0, v219
    v_rcp_f32 v216, v216
    v_rcp_f32 v217, v217
    v_rcp_f32 v218, v218
    v_rcp_f32 v219, v219
    v_mul_f32 v208, v208, v216
    v_mul_f32 v209, v209, v217
    v_mul_f32 v210, v210, v218
    v_mul_f32 v211, v211, v219
    v_cvt_pk_bf16_f32 v226, v208, v209
    v_cvt_pk_bf16_f32 v227, v210, v211
    buffer_store_dwordx4 v[224:227], v181, s[16:19], s49 offen offset:2048 sc1
    s_setprio 0
    s_load_dwordx2 s[34:35], s[0:1], 104
    s_load_dwordx2 s[4:5], s[0:1], 0
    s_load_dwordx2 s[6:7], s[0:1], 80
    s_load_dwordx2 s[32:33], s[0:1], 88
    s_and_b32 s27, s2, 7
    s_lshr_b32 s28, s2, 3
    s_and_b32 s25, s27, 1
    s_lshl_b32 s25, s25, 2
    s_and_b32 s29, s28, 3
    s_add_u32 s25, s25, s29
    s_lshr_b32 s26, s27, 1
    s_lshl_b32 s26, s26, 3
    s_lshr_b32 s29, s28, 2
    s_add_u32 s26, s26, s29
    s_mul_i32 s36, s24, 12
    s_add_u32 s29, s24, 0
    s_and_b32 s29, s29, 3
    s_lshl_b32 s30, s26, 2
    s_add_u32 s29, s29, s30
    s_mul_i32 s29, s29, 48
    s_add_u32 s29, s29, s36
    s_lshl_b32 s40, s29, 10
    s_add_u32 s29, s24, 1
    s_and_b32 s29, s29, 3
    s_lshl_b32 s30, s26, 2
    s_add_u32 s29, s29, s30
    s_mul_i32 s29, s29, 48
    s_add_u32 s29, s29, s36
    s_lshl_b32 s41, s29, 10
    s_add_u32 s29, s24, 2
    s_and_b32 s29, s29, 3
    s_lshl_b32 s30, s26, 2
    s_add_u32 s29, s29, s30
    s_mul_i32 s29, s29, 48
    s_add_u32 s29, s29, s36
    s_lshl_b32 s42, s29, 10
    s_add_u32 s29, s24, 3
    s_and_b32 s29, s29, 3
    s_lshl_b32 s30, s26, 2
    s_add_u32 s29, s29, s30
    s_mul_i32 s29, s29, 48
    s_add_u32 s29, s29, s36
    s_lshl_b32 s43, s29, 10
    s_mul_i32 s29, s25, 48
    s_add_u32 s29, s29, s36
    s_mul_i32 s44, s29, 5120
    s_add_u32 s44, s44, 6291456
    v_lshlrev_b32 v4, 4, v1
    v_add_u32 v5, 4096, v4
    s_waitcnt lgkmcnt(0)
    s_mov_b32 s16, s34
    s_mov_b32 s17, s35
    s_mov_b32 s18, 13680640
    s_mov_b32 s19, 0x00020000
    s_mov_b32 s8, s4
    s_mov_b32 s9, s5
    s_mov_b32 s10, 2621440
    s_mov_b32 s11, 0x00020000
    s_mov_b32 s12, s6
    s_mov_b32 s13, s7
    s_mov_b32 s14, 1280
    s_mov_b32 s15, 0x00020000
    s_mov_b32 s20, s32
    s_mov_b32 s21, s33
    s_mov_b32 s22, 2621440
    s_mov_b32 s23, 0x00020000
    s_waitcnt vmcnt(0)
    v_mov_b32 v248, 115096
    v_mov_b32 v250, 1
    s_mov_b64 exec, 1
    ds_add_rtn_u32 v244, v248, v250
    s_waitcnt lgkmcnt(0)
    v_readfirstlane_b32 s38, v244
    s_cmp_lg_u32 s38, 3
    s_cbranch_scc1 B_nohflag
    v_mov_b32 v249, 115092
B_hgo:
    ds_read_b32 v244, v249
    s_waitcnt lgkmcnt(0)
    v_cmp_gt_u32 vcc, 1, v244
    s_nop 1
    s_cbranch_vccz B_hgo_ok
    s_sleep 2
    s_branch B_hgo
B_hgo_ok:
    v_mov_b32 v246, 0
    s_lshl_b32 s38, s2, 7
    s_add_u32 s38, s38, 13516804
    buffer_store_dword v250, v246, s[16:19], s38 offen sc1
B_nohflag:
    s_mov_b64 exec, -1
    v_mov_b32 v249, 115112
B_wrdy:
    ds_read_b32 v244, v249
    s_waitcnt lgkmcnt(0)
    v_cmp_gt_u32 vcc, 1, v244
    s_nop 1
    s_cbranch_vccz B_wrdy_ok
    s_sleep 2
    s_branch B_wrdy
B_wrdy_ok:
    buffer_load_dwordx4 v[104:107], v4, s[16:19], s44 offen offset:0
    buffer_load_dwordx4 v[108:111], v4, s[16:19], s44 offen offset:1024
    buffer_load_dwordx4 v[112:115], v4, s[16:19], s44 offen offset:2048
    buffer_load_dwordx4 v[116:119], v4, s[16:19], s44 offen offset:3072
    buffer_load_dwordx4 v[120:123], v5, s[16:19], s44 offen offset:0
    s_add_u32 s44, s44, 5120
    buffer_load_dwordx4 v[140:143], v4, s[16:19], s44 offen offset:0
    buffer_load_dwordx4 v[144:147], v4, s[16:19], s44 offen offset:1024
    buffer_load_dwordx4 v[148:151], v4, s[16:19], s44 offen offset:2048
    buffer_load_dwordx4 v[152:155], v4, s[16:19], s44 offen offset:3072
    buffer_load_dwordx4 v[156:159], v5, s[16:19], s44 offen offset:0
    s_add_u32 s44, s44, 5120
    buffer_load_dwordx4 v[176:179], v4, s[16:19], s44 offen offset:0
    buffer_load_dwordx4 v[180:183], v4, s[16:19], s44 offen offset:1024
    buffer_load_dwordx4 v[184:187], v4, s[16:19], s44 offen offset:2048
    buffer_load_dwordx4 v[188:191], v4, s[16:19], s44 offen offset:3072
    buffer_load_dwordx4 v[192:195], v5, s[16:19], s44 offen offset:0
    s_add_u32 s44, s44, 5120
    v_mov_b32 v8, 0
    v_mov_b32 v9, 0
    v_mov_b32 v10, 0
    v_mov_b32 v11, 0
    v_mov_b32 v12, 0
    v_mov_b32 v13, 0
    v_mov_b32 v14, 0
    v_mov_b32 v15, 0
    v_mov_b32 v16, 0
    v_mov_b32 v17, 0
    v_mov_b32 v18, 0
    v_mov_b32 v19, 0
    v_mov_b32 v20, 0
    v_mov_b32 v21, 0
    v_mov_b32 v22, 0
    v_mov_b32 v23, 0
    v_mov_b32 v24, 0
    v_mov_b32 v25, 0
    v_mov_b32 v26, 0
    v_mov_b32 v27, 0
    v_mov_b32 v28, 0
    v_mov_b32 v29, 0
    v_mov_b32 v30, 0
    v_mov_b32 v31, 0
    v_mov_b32 v32, 0
    v_mov_b32 v33, 0
    v_mov_b32 v34, 0
    v_mov_b32 v35, 0
    v_mov_b32 v36, 0
    v_mov_b32 v37, 0
    v_mov_b32 v38, 0
    v_mov_b32 v39, 0
    v_mov_b32 v40, 0
    v_mov_b32 v41, 0
    v_mov_b32 v42, 0
    v_mov_b32 v43, 0
    v_mov_b32 v44, 0
    v_mov_b32 v45, 0
    v_mov_b32 v46, 0
    v_mov_b32 v47, 0
    v_mov_b32 v48, 0
    v_mov_b32 v49, 0
    v_mov_b32 v50, 0
    v_mov_b32 v51, 0
    v_mov_b32 v52, 0
    v_mov_b32 v53, 0
    v_mov_b32 v54, 0
    v_mov_b32 v55, 0
    v_mov_b32 v56, 0
    v_mov_b32 v57, 0
    v_mov_b32 v58, 0
    v_mov_b32 v59, 0
    v_mov_b32 v60, 0
    v_mov_b32 v61, 0
    v_mov_b32 v62, 0
    v_mov_b32 v63, 0
    v_mov_b32 v64, 0
    v_mov_b32 v65, 0
    v_mov_b32 v66, 0
    v_mov_b32 v67, 0
    v_mov_b32 v68, 0
    v_mov_b32 v69, 0
    v_mov_b32 v70, 0
    v_mov_b32 v71, 0
    v_mov_b32 v72, 0
    v_mov_b32 v73, 0
    v_mov_b32 v74, 0
    v_mov_b32 v75, 0
    v_mov_b32 v76, 0
    v_mov_b32 v77, 0
    v_mov_b32 v78, 0
    v_mov_b32 v79, 0
    v_mov_b32 v80, 0
    v_mov_b32 v81, 0
    v_mov_b32 v82, 0
    v_mov_b32 v83, 0
    v_mov_b32 v84, 0
    v_mov_b32 v85, 0
    v_mov_b32 v86, 0
    v_mov_b32 v87, 0
    v_mov_b32 v249, 115104
B_hrdy:
    ds_read_b32 v244, v249
    s_waitcnt lgkmcnt(0)
    v_cmp_gt_u32 vcc, 1, v244
    s_nop 1
    s_cbranch_vccz B_hrdy_ok
    s_sleep 1
    s_branch B_hrdy
B_hrdy_ok:
    buffer_load_dwordx4 v[88:91], v4, s[16:19], s40 offen
    s_add_u32 s40, s40, 1024
    buffer_load_dwordx4 v[92:95], v4, s[16:19], s41 offen
    s_add_u32 s41, s41, 1024
    buffer_load_dwordx4 v[96:99], v4, s[16:19], s42 offen
    s_add_u32 s42, s42, 1024
    buffer_load_dwordx4 v[100:103], v4, s[16:19], s43 offen
    s_add_u32 s43, s43, 1024
    buffer_load_dwordx4 v[124:127], v4, s[16:19], s40 offen
    s_add_u32 s40, s40, 1024
    buffer_load_dwordx4 v[128:131], v4, s[16:19], s41 offen
    s_add_u32 s41, s41, 1024
    buffer_load_dwordx4 v[132:135], v4, s[16:19], s42 offen
    s_add_u32 s42, s42, 1024
    buffer_load_dwordx4 v[136:139], v4, s[16:19], s43 offen
    s_add_u32 s43, s43, 1024
    buffer_load_dwordx4 v[160:163], v4, s[16:19], s40 offen
    s_add_u32 s40, s40, 1024
    buffer_load_dwordx4 v[164:167], v4, s[16:19], s41 offen
    s_add_u32 s41, s41, 1024
    buffer_load_dwordx4 v[168:171], v4, s[16:19], s42 offen
    s_add_u32 s42, s42, 1024
    buffer_load_dwordx4 v[172:175], v4, s[16:19], s43 offen
    s_add_u32 s43, s43, 1024
    s_mul_i32 s29, s24, 25600
    v_add_u32 v6, s29, v4
    s_lshl_b32 s29, s24, 2
    s_add_u32 s29, s29, 115072
    v_mov_b32 v248, s29
    s_waitcnt vmcnt(8)
    v_mfma_f32_16x16x32_bf16 v[8:11], v[104:107], v[88:91], v[8:11]
    v_mfma_f32_16x16x32_bf16 v[28:31], v[104:107], v[92:95], v[28:31]
    buffer_load_dwordx4 v[196:199], v4, s[16:19], s40 offen
    s_add_u32 s40, s40, 1024
    v_mfma_f32_16x16x32_bf16 v[48:51], v[104:107], v[96:99], v[48:51]
    v_mfma_f32_16x16x32_bf16 v[68:71], v[104:107], v[100:103], v[68:71]
    buffer_load_dwordx4 v[200:203], v4, s[16:19], s41 offen
    s_add_u32 s41, s41, 1024
    v_mfma_f32_16x16x32_bf16 v[12:15], v[108:111], v[88:91], v[12:15]
    v_mfma_f32_16x16x32_bf16 v[32:35], v[108:111], v[92:95], v[32:35]
    buffer_load_dwordx4 v[204:207], v4, s[16:19], s42 offen
    s_add_u32 s42, s42, 1024
    v_mfma_f32_16x16x32_bf16 v[52:55], v[108:111], v[96:99], v[52:55]
    v_mfma_f32_16x16x32_bf16 v[72:75], v[108:111], v[100:103], v[72:75]
    buffer_load_dwordx4 v[208:211], v4, s[16:19], s43 offen
    s_add_u32 s43, s43, 1024
    v_mfma_f32_16x16x32_bf16 v[16:19], v[112:115], v[88:91], v[16:19]
    v_mfma_f32_16x16x32_bf16 v[36:39], v[112:115], v[92:95], v[36:39]
    ds_read_b128 v[212:215], v6 offset:0
    v_mfma_f32_16x16x32_bf16 v[56:59], v[112:115], v[96:99], v[56:59]
    v_mfma_f32_16x16x32_bf16 v[76:79], v[112:115], v[100:103], v[76:79]
    ds_read_b128 v[216:219], v6 offset:1024
    v_mfma_f32_16x16x32_bf16 v[20:23], v[116:119], v[88:91], v[20:23]
    v_mfma_f32_16x16x32_bf16 v[40:43], v[116:119], v[92:95], v[40:43]
    ds_read_b128 v[220:223], v6 offset:2048
    v_mfma_f32_16x16x32_bf16 v[60:63], v[116:119], v[96:99], v[60:63]
    v_mfma_f32_16x16x32_bf16 v[80:83], v[116:119], v[100:103], v[80:83]
    ds_read_b128 v[224:227], v6 offset:3072
    v_mfma_f32_16x16x32_bf16 v[24:27], v[120:123], v[88:91], v[24:27]
    v_mfma_f32_16x16x32_bf16 v[44:47], v[120:123], v[92:95], v[44:47]
    ds_read_b128 v[228:231], v6 offset:4096
    s_add_u32 s44, s44, 5120
    v_mfma_f32_16x16x32_bf16 v[64:67], v[120:123], v[96:99], v[64:67]
    v_mfma_f32_16x16x32_bf16 v[84:87], v[120:123], v[100:103], v[84:87]
    s_waitcnt vmcnt(8) lgkmcnt(0)
    v_mfma_f32_16x16x32_bf16 v[8:11], v[140:143], v[124:127], v[8:11]
    v_mfma_f32_16x16x32_bf16 v[28:31], v[140:143], v[128:131], v[28:31]
    buffer_load_dwordx4 v[88:91], v4, s[16:19], s40 offen
    s_add_u32 s40, s40, 1024
    v_mfma_f32_16x16x32_bf16 v[48:51], v[140:143], v[132:135], v[48:51]
    v_mfma_f32_16x16x32_bf16 v[68:71], v[140:143], v[136:139], v[68:71]
    buffer_load_dwordx4 v[92:95], v4, s[16:19], s41 offen
    s_add_u32 s41, s41, 1024
    v_mfma_f32_16x16x32_bf16 v[12:15], v[144:147], v[124:127], v[12:15]
    v_mfma_f32_16x16x32_bf16 v[32:35], v[144:147], v[128:131], v[32:35]
    buffer_load_dwordx4 v[96:99], v4, s[16:19], s42 offen
    s_add_u32 s42, s42, 1024
    v_mfma_f32_16x16x32_bf16 v[52:55], v[144:147], v[132:135], v[52:55]
    v_mfma_f32_16x16x32_bf16 v[72:75], v[144:147], v[136:139], v[72:75]
    buffer_load_dwordx4 v[100:103], v4, s[16:19], s43 offen
    s_add_u32 s43, s43, 1024
    v_mfma_f32_16x16x32_bf16 v[16:19], v[148:151], v[124:127], v[16:19]
    v_mfma_f32_16x16x32_bf16 v[36:39], v[148:151], v[128:131], v[36:39]
    ds_read_b128 v[104:107], v6 offset:5120
    v_mfma_f32_16x16x32_bf16 v[56:59], v[148:151], v[132:135], v[56:59]
    v_mfma_f32_16x16x32_bf16 v[76:79], v[148:151], v[136:139], v[76:79]
    ds_read_b128 v[108:111], v6 offset:6144
    v_mfma_f32_16x16x32_bf16 v[20:23], v[152:155], v[124:127], v[20:23]
    v_mfma_f32_16x16x32_bf16 v[40:43], v[152:155], v[128:131], v[40:43]
    ds_read_b128 v[112:115], v6 offset:7168
    v_mfma_f32_16x16x32_bf16 v[60:63], v[152:155], v[132:135], v[60:63]
    v_mfma_f32_16x16x32_bf16 v[80:83], v[152:155], v[136:139], v[80:83]
    ds_read_b128 v[116:119], v6 offset:8192
    v_mfma_f32_16x16x32_bf16 v[24:27], v[156:159], v[124:127], v[24:27]
    v_mfma_f32_16x16x32_bf16 v[44:47], v[156:159], v[128:131], v[44:47]
    ds_read_b128 v[120:123], v6 offset:9216
    s_add_u32 s44, s44, 5120
    v_mfma_f32_16x16x32_bf16 v[64:67], v[156:159], v[132:135], v[64:67]
    v_mfma_f32_16x16x32_bf16 v[84:87], v[156:159], v[136:139], v[84:87]
    s_waitcnt vmcnt(8) lgkmcnt(0)
    v_mfma_f32_16x16x32_bf16 v[8:11], v[176:179], v[160:163], v[8:11]
    v_mfma_f32_16x16x32_bf16 v[28:31], v[176:179], v[164:167], v[28:31]
    buffer_load_dwordx4 v[124:127], v4, s[16:19], s40 offen
    s_add_u32 s40, s40, 1024
    v_mfma_f32_16x16x32_bf16 v[48:51], v[176:179], v[168:171], v[48:51]
    v_mfma_f32_16x16x32_bf16 v[68:71], v[176:179], v[172:175], v[68:71]
    buffer_load_dwordx4 v[128:131], v4, s[16:19], s41 offen
    s_add_u32 s41, s41, 1024
    v_mfma_f32_16x16x32_bf16 v[12:15], v[180:183], v[160:163], v[12:15]
    v_mfma_f32_16x16x32_bf16 v[32:35], v[180:183], v[164:167], v[32:35]
    buffer_load_dwordx4 v[132:135], v4, s[16:19], s42 offen
    s_add_u32 s42, s42, 1024
    v_mfma_f32_16x16x32_bf16 v[52:55], v[180:183], v[168:171], v[52:55]
    v_mfma_f32_16x16x32_bf16 v[72:75], v[180:183], v[172:175], v[72:75]
    buffer_load_dwordx4 v[136:139], v4, s[16:19], s43 offen
    s_add_u32 s43, s43, 1024
    v_mfma_f32_16x16x32_bf16 v[16:19], v[184:187], v[160:163], v[16:19]
    v_mfma_f32_16x16x32_bf16 v[36:39], v[184:187], v[164:167], v[36:39]
    ds_read_b128 v[140:143], v6 offset:10240
    v_mfma_f32_16x16x32_bf16 v[56:59], v[184:187], v[168:171], v[56:59]
    v_mfma_f32_16x16x32_bf16 v[76:79], v[184:187], v[172:175], v[76:79]
    ds_read_b128 v[144:147], v6 offset:11264
    v_mfma_f32_16x16x32_bf16 v[20:23], v[188:191], v[160:163], v[20:23]
    v_mfma_f32_16x16x32_bf16 v[40:43], v[188:191], v[164:167], v[40:43]
    ds_read_b128 v[148:151], v6 offset:12288
    v_mfma_f32_16x16x32_bf16 v[60:63], v[188:191], v[168:171], v[60:63]
    v_mfma_f32_16x16x32_bf16 v[80:83], v[188:191], v[172:175], v[80:83]
    ds_read_b128 v[152:155], v6 offset:13312
    v_mfma_f32_16x16x32_bf16 v[24:27], v[192:195], v[160:163], v[24:27]
    v_mfma_f32_16x16x32_bf16 v[44:47], v[192:195], v[164:167], v[44:47]
    ds_read_b128 v[156:159], v6 offset:14336
    s_add_u32 s44, s44, 5120
    v_mfma_f32_16x16x32_bf16 v[64:67], v[192:195], v[168:171], v[64:67]
    v_mfma_f32_16x16x32_bf16 v[84:87], v[192:195], v[172:175], v[84:87]
    s_waitcnt vmcnt(8) lgkmcnt(0)
    v_mfma_f32_16x16x32_bf16 v[8:11], v[212:215], v[196:199], v[8:11]
    v_mfma_f32_16x16x32_bf16 v[28:31], v[212:215], v[200:203], v[28:31]
    buffer_load_dwordx4 v[160:163], v4, s[16:19], s40 offen
    s_add_u32 s40, s40, 1024
    v_mfma_f32_16x16x32_bf16 v[48:51], v[212:215], v[204:207], v[48:51]
    v_mfma_f32_16x16x32_bf16 v[68:71], v[212:215], v[208:211], v[68:71]
    buffer_load_dwordx4 v[164:167], v4, s[16:19], s41 offen
    s_add_u32 s41, s41, 1024
    v_mfma_f32_16x16x32_bf16 v[12:15], v[216:219], v[196:199], v[12:15]
    v_mfma_f32_16x16x32_bf16 v[32:35], v[216:219], v[200:203], v[32:35]
    buffer_load_dwordx4 v[168:171], v4, s[16:19], s42 offen
    s_add_u32 s42, s42, 1024
    v_mfma_f32_16x16x32_bf16 v[52:55], v[216:219], v[204:207], v[52:55]
    v_mfma_f32_16x16x32_bf16 v[72:75], v[216:219], v[208:211], v[72:75]
    buffer_load_dwordx4 v[172:175], v4, s[16:19], s43 offen
    s_add_u32 s43, s43, 1024
    v_mfma_f32_16x16x32_bf16 v[16:19], v[220:223], v[196:199], v[16:19]
    v_mfma_f32_16x16x32_bf16 v[36:39], v[220:223], v[200:203], v[36:39]
    ds_read_b128 v[176:179], v6 offset:15360
    v_mfma_f32_16x16x32_bf16 v[56:59], v[220:223], v[204:207], v[56:59]
    v_mfma_f32_16x16x32_bf16 v[76:79], v[220:223], v[208:211], v[76:79]
    ds_read_b128 v[180:183], v6 offset:16384
    v_mfma_f32_16x16x32_bf16 v[20:23], v[224:227], v[196:199], v[20:23]
    v_mfma_f32_16x16x32_bf16 v[40:43], v[224:227], v[200:203], v[40:43]
    ds_read_b128 v[184:187], v6 offset:17408
    v_mfma_f32_16x16x32_bf16 v[60:63], v[224:227], v[204:207], v[60:63]
    v_mfma_f32_16x16x32_bf16 v[80:83], v[224:227], v[208:211], v[80:83]
    ds_read_b128 v[188:191], v6 offset:18432
    v_mfma_f32_16x16x32_bf16 v[24:27], v[228:231], v[196:199], v[24:27]
    v_mfma_f32_16x16x32_bf16 v[44:47], v[228:231], v[200:203], v[44:47]
    ds_read_b128 v[192:195], v6 offset:19456
    s_add_u32 s44, s44, 5120
    v_mfma_f32_16x16x32_bf16 v[64:67], v[228:231], v[204:207], v[64:67]
    v_mfma_f32_16x16x32_bf16 v[84:87], v[228:231], v[208:211], v[84:87]
    s_waitcnt vmcnt(8) lgkmcnt(0)
    v_mfma_f32_16x16x32_bf16 v[8:11], v[104:107], v[88:91], v[8:11]
    v_mfma_f32_16x16x32_bf16 v[28:31], v[104:107], v[92:95], v[28:31]
    buffer_load_dwordx4 v[196:199], v4, s[16:19], s40 offen
    s_add_u32 s40, s40, 1024
    v_mfma_f32_16x16x32_bf16 v[48:51], v[104:107], v[96:99], v[48:51]
    v_mfma_f32_16x16x32_bf16 v[68:71], v[104:107], v[100:103], v[68:71]
    buffer_load_dwordx4 v[200:203], v4, s[16:19], s41 offen
    s_add_u32 s41, s41, 1024
    v_mfma_f32_16x16x32_bf16 v[12:15], v[108:111], v[88:91], v[12:15]
    v_mfma_f32_16x16x32_bf16 v[32:35], v[108:111], v[92:95], v[32:35]
    buffer_load_dwordx4 v[204:207], v4, s[16:19], s42 offen
    s_add_u32 s42, s42, 1024
    v_mfma_f32_16x16x32_bf16 v[52:55], v[108:111], v[96:99], v[52:55]
    v_mfma_f32_16x16x32_bf16 v[72:75], v[108:111], v[100:103], v[72:75]
    buffer_load_dwordx4 v[208:211], v4, s[16:19], s43 offen
    s_add_u32 s43, s43, 1024
    v_mfma_f32_16x16x32_bf16 v[16:19], v[112:115], v[88:91], v[16:19]
    v_mfma_f32_16x16x32_bf16 v[36:39], v[112:115], v[92:95], v[36:39]
    ds_read_b128 v[212:215], v6 offset:20480
    v_mfma_f32_16x16x32_bf16 v[56:59], v[112:115], v[96:99], v[56:59]
    v_mfma_f32_16x16x32_bf16 v[76:79], v[112:115], v[100:103], v[76:79]
    ds_read_b128 v[216:219], v6 offset:21504
    v_mfma_f32_16x16x32_bf16 v[20:23], v[116:119], v[88:91], v[20:23]
    v_mfma_f32_16x16x32_bf16 v[40:43], v[116:119], v[92:95], v[40:43]
    ds_read_b128 v[220:223], v6 offset:22528
    v_mfma_f32_16x16x32_bf16 v[60:63], v[116:119], v[96:99], v[60:63]
    v_mfma_f32_16x16x32_bf16 v[80:83], v[116:119], v[100:103], v[80:83]
    ds_read_b128 v[224:227], v6 offset:23552
    v_mfma_f32_16x16x32_bf16 v[24:27], v[120:123], v[88:91], v[24:27]
    v_mfma_f32_16x16x32_bf16 v[44:47], v[120:123], v[92:95], v[44:47]
    ds_read_b128 v[228:231], v6 offset:24576
    s_add_u32 s44, s44, 5120
    v_mfma_f32_16x16x32_bf16 v[64:67], v[120:123], v[96:99], v[64:67]
    v_mfma_f32_16x16x32_bf16 v[84:87], v[120:123], v[100:103], v[84:87]
    s_waitcnt vmcnt(8) lgkmcnt(0)
    v_mov_b32 v250, 13
    s_mov_b64 exec, 1
    ds_write_b32 v248, v250
    s_mov_b64 exec, -1
    v_mfma_f32_16x16x32_bf16 v[8:11], v[140:143], v[124:127], v[8:11]
    v_mfma_f32_16x16x32_bf16 v[28:31], v[140:143], v[128:131], v[28:31]
    buffer_load_dwordx4 v[104:107], v4, s[16:19], s44 offen offset:0
    v_mfma_f32_16x16x32_bf16 v[48:51], v[140:143], v[132:135], v[48:51]
    v_mfma_f32_16x16x32_bf16 v[68:71], v[140:143], v[136:139], v[68:71]
    buffer_load_dwordx4 v[108:111], v4, s[16:19], s44 offen offset:1024
    v_mfma_f32_16x16x32_bf16 v[12:15], v[144:147], v[124:127], v[12:15]
    v_mfma_f32_16x16x32_bf16 v[32:35], v[144:147], v[128:131], v[32:35]
    buffer_load_dwordx4 v[112:115], v4, s[16:19], s44 offen offset:2048
    v_mfma_f32_16x16x32_bf16 v[52:55], v[144:147], v[132:135], v[52:55]
    v_mfma_f32_16x16x32_bf16 v[72:75], v[144:147], v[136:139], v[72:75]
    buffer_load_dwordx4 v[116:119], v4, s[16:19], s44 offen offset:3072
    v_mfma_f32_16x16x32_bf16 v[16:19], v[148:151], v[124:127], v[16:19]
    v_mfma_f32_16x16x32_bf16 v[36:39], v[148:151], v[128:131], v[36:39]
    buffer_load_dwordx4 v[120:123], v5, s[16:19], s44 offen offset:0
    s_add_u32 s44, s44, 5120
    v_mfma_f32_16x16x32_bf16 v[56:59], v[148:151], v[132:135], v[56:59]
    v_mfma_f32_16x16x32_bf16 v[76:79], v[148:151], v[136:139], v[76:79]
    buffer_load_dwordx4 v[88:91], v4, s[16:19], s40 offen
    s_add_u32 s40, s40, 1024
    v_mfma_f32_16x16x32_bf16 v[20:23], v[152:155], v[124:127], v[20:23]
    v_mfma_f32_16x16x32_bf16 v[40:43], v[152:155], v[128:131], v[40:43]
    buffer_load_dwordx4 v[92:95], v4, s[16:19], s41 offen
    s_add_u32 s41, s41, 1024
    v_mfma_f32_16x16x32_bf16 v[60:63], v[152:155], v[132:135], v[60:63]
    v_mfma_f32_16x16x32_bf16 v[80:83], v[152:155], v[136:139], v[80:83]
    buffer_load_dwordx4 v[96:99], v4, s[16:19], s42 offen
    s_add_u32 s42, s42, 1024
    v_mfma_f32_16x16x32_bf16 v[24:27], v[156:159], v[124:127], v[24:27]
    v_mfma_f32_16x16x32_bf16 v[44:47], v[156:159], v[128:131], v[44:47]
    buffer_load_dwordx4 v[100:103], v4, s[16:19], s43 offen
    s_add_u32 s43, s43, 1024
    v_mfma_f32_16x16x32_bf16 v[64:67], v[156:159], v[132:135], v[64:67]
    v_mfma_f32_16x16x32_bf16 v[84:87], v[156:159], v[136:139], v[84:87]
    s_waitcnt vmcnt(13) lgkmcnt(0)
    v_mfma_f32_16x16x32_bf16 v[8:11], v[176:179], v[160:163], v[8:11]
    v_mfma_f32_16x16x32_bf16 v[28:31], v[176:179], v[164:167], v[28:31]
    buffer_load_dwordx4 v[140:143], v4, s[16:19], s44 offen offset:0
    v_mfma_f32_16x16x32_bf16 v[48:51], v[176:179], v[168:171], v[48:51]
    v_mfma_f32_16x16x32_bf16 v[68:71], v[176:179], v[172:175], v[68:71]
    buffer_load_dwordx4 v[144:147], v4, s[16:19], s44 offen offset:1024
    v_mfma_f32_16x16x32_bf16 v[12:15], v[180:183], v[160:163], v[12:15]
    v_mfma_f32_16x16x32_bf16 v[32:35], v[180:183], v[164:167], v[32:35]
    buffer_load_dwordx4 v[148:151], v4, s[16:19], s44 offen offset:2048
    v_mfma_f32_16x16x32_bf16 v[52:55], v[180:183], v[168:171], v[52:55]
    v_mfma_f32_16x16x32_bf16 v[72:75], v[180:183], v[172:175], v[72:75]
    buffer_load_dwordx4 v[152:155], v4, s[16:19], s44 offen offset:3072
    v_mfma_f32_16x16x32_bf16 v[16:19], v[184:187], v[160:163], v[16:19]
    v_mfma_f32_16x16x32_bf16 v[36:39], v[184:187], v[164:167], v[36:39]
    buffer_load_dwordx4 v[156:159], v5, s[16:19], s44 offen offset:0
    s_add_u32 s44, s44, 5120
    v_mfma_f32_16x16x32_bf16 v[56:59], v[184:187], v[168:171], v[56:59]
    v_mfma_f32_16x16x32_bf16 v[76:79], v[184:187], v[172:175], v[76:79]
    buffer_load_dwordx4 v[124:127], v4, s[16:19], s40 offen
    s_add_u32 s40, s40, 1024
    v_mfma_f32_16x16x32_bf16 v[20:23], v[188:191], v[160:163], v[20:23]
    v_mfma_f32_16x16x32_bf16 v[40:43], v[188:191], v[164:167], v[40:43]
    buffer_load_dwordx4 v[128:131], v4, s[16:19], s41 offen
    s_add_u32 s41, s41, 1024
    v_mfma_f32_16x16x32_bf16 v[60:63], v[188:191], v[168:171], v[60:63]
    v_mfma_f32_16x16x32_bf16 v[80:83], v[188:191], v[172:175], v[80:83]
    buffer_load_dwordx4 v[132:135], v4, s[16:19], s42 offen
    s_add_u32 s42, s42, 1024
    v_mfma_f32_16x16x32_bf16 v[24:27], v[192:195], v[160:163], v[24:27]
    v_mfma_f32_16x16x32_bf16 v[44:47], v[192:195], v[164:167], v[44:47]
    buffer_load_dwordx4 v[136:139], v4, s[16:19], s43 offen
    s_add_u32 s43, s43, 1024
    v_mfma_f32_16x16x32_bf16 v[64:67], v[192:195], v[168:171], v[64:67]
    v_mfma_f32_16x16x32_bf16 v[84:87], v[192:195], v[172:175], v[84:87]
    s_waitcnt vmcnt(18) lgkmcnt(0)
    v_mfma_f32_16x16x32_bf16 v[8:11], v[212:215], v[196:199], v[8:11]
    v_mfma_f32_16x16x32_bf16 v[28:31], v[212:215], v[200:203], v[28:31]
    buffer_load_dwordx4 v[176:179], v4, s[16:19], s44 offen offset:0
    v_mfma_f32_16x16x32_bf16 v[48:51], v[212:215], v[204:207], v[48:51]
    v_mfma_f32_16x16x32_bf16 v[68:71], v[212:215], v[208:211], v[68:71]
    buffer_load_dwordx4 v[180:183], v4, s[16:19], s44 offen offset:1024
    v_mfma_f32_16x16x32_bf16 v[12:15], v[216:219], v[196:199], v[12:15]
    v_mfma_f32_16x16x32_bf16 v[32:35], v[216:219], v[200:203], v[32:35]
    buffer_load_dwordx4 v[184:187], v4, s[16:19], s44 offen offset:2048
    v_mfma_f32_16x16x32_bf16 v[52:55], v[216:219], v[204:207], v[52:55]
    v_mfma_f32_16x16x32_bf16 v[72:75], v[216:219], v[208:211], v[72:75]
    buffer_load_dwordx4 v[188:191], v4, s[16:19], s44 offen offset:3072
    v_mfma_f32_16x16x32_bf16 v[16:19], v[220:223], v[196:199], v[16:19]
    v_mfma_f32_16x16x32_bf16 v[36:39], v[220:223], v[200:203], v[36:39]
    buffer_load_dwordx4 v[192:195], v5, s[16:19], s44 offen offset:0
    s_add_u32 s44, s44, 5120
    v_mfma_f32_16x16x32_bf16 v[56:59], v[220:223], v[204:207], v[56:59]
    v_mfma_f32_16x16x32_bf16 v[76:79], v[220:223], v[208:211], v[76:79]
    buffer_load_dwordx4 v[160:163], v4, s[16:19], s40 offen
    s_add_u32 s40, s40, 1024
    v_mfma_f32_16x16x32_bf16 v[20:23], v[224:227], v[196:199], v[20:23]
    v_mfma_f32_16x16x32_bf16 v[40:43], v[224:227], v[200:203], v[40:43]
    buffer_load_dwordx4 v[164:167], v4, s[16:19], s41 offen
    s_add_u32 s41, s41, 1024
    v_mfma_f32_16x16x32_bf16 v[60:63], v[224:227], v[204:207], v[60:63]
    v_mfma_f32_16x16x32_bf16 v[80:83], v[224:227], v[208:211], v[80:83]
    buffer_load_dwordx4 v[168:171], v4, s[16:19], s42 offen
    s_add_u32 s42, s42, 1024
    v_mfma_f32_16x16x32_bf16 v[24:27], v[228:231], v[196:199], v[24:27]
    v_mfma_f32_16x16x32_bf16 v[44:47], v[228:231], v[200:203], v[44:47]
    buffer_load_dwordx4 v[172:175], v4, s[16:19], s43 offen
    s_add_u32 s43, s43, 1024
    v_mfma_f32_16x16x32_bf16 v[64:67], v[228:231], v[204:207], v[64:67]
    v_mfma_f32_16x16x32_bf16 v[84:87], v[228:231], v[208:211], v[84:87]
    s_waitcnt vmcnt(18)
    v_mfma_f32_16x16x32_bf16 v[8:11], v[104:107], v[88:91], v[8:11]
    v_mfma_f32_16x16x32_bf16 v[28:31], v[104:107], v[92:95], v[28:31]
    buffer_load_dwordx4 v[212:215], v4, s[16:19], s44 offen offset:0
    v_mfma_f32_16x16x32_bf16 v[48:51], v[104:107], v[96:99], v[48:51]
    v_mfma_f32_16x16x32_bf16 v[68:71], v[104:107], v[100:103], v[68:71]
    buffer_load_dwordx4 v[216:219], v4, s[16:19], s44 offen offset:1024
    v_mfma_f32_16x16x32_bf16 v[12:15], v[108:111], v[88:91], v[12:15]
    v_mfma_f32_16x16x32_bf16 v[32:35], v[108:111], v[92:95], v[32:35]
    buffer_load_dwordx4 v[220:223], v4, s[16:19], s44 offen offset:2048
    v_mfma_f32_16x16x32_bf16 v[52:55], v[108:111], v[96:99], v[52:55]
    v_mfma_f32_16x16x32_bf16 v[72:75], v[108:111], v[100:103], v[72:75]
    buffer_load_dwordx4 v[224:227], v4, s[16:19], s44 offen offset:3072
    v_mfma_f32_16x16x32_bf16 v[16:19], v[112:115], v[88:91], v[16:19]
    v_mfma_f32_16x16x32_bf16 v[36:39], v[112:115], v[92:95], v[36:39]
    buffer_load_dwordx4 v[228:231], v5, s[16:19], s44 offen offset:0
    s_add_u32 s44, s44, 5120
    v_mfma_f32_16x16x32_bf16 v[56:59], v[112:115], v[96:99], v[56:59]
    v_mfma_f32_16x16x32_bf16 v[76:79], v[112:115], v[100:103], v[76:79]
    buffer_load_dwordx4 v[196:199], v4, s[16:19], s40 offen
    s_add_u32 s40, s40, 1024
    v_mfma_f32_16x16x32_bf16 v[20:23], v[116:119], v[88:91], v[20:23]
    v_mfma_f32_16x16x32_bf16 v[40:43], v[116:119], v[92:95], v[40:43]
    buffer_load_dwordx4 v[200:203], v4, s[16:19], s41 offen
    s_add_u32 s41, s41, 1024
    v_mfma_f32_16x16x32_bf16 v[60:63], v[116:119], v[96:99], v[60:63]
    v_mfma_f32_16x16x32_bf16 v[80:83], v[116:119], v[100:103], v[80:83]
    buffer_load_dwordx4 v[204:207], v4, s[16:19], s42 offen
    s_add_u32 s42, s42, 1024
    v_mfma_f32_16x16x32_bf16 v[24:27], v[120:123], v[88:91], v[24:27]
    v_mfma_f32_16x16x32_bf16 v[44:47], v[120:123], v[92:95], v[44:47]
    buffer_load_dwordx4 v[208:211], v4, s[16:19], s43 offen
    s_add_u32 s43, s43, 1024
    v_mfma_f32_16x16x32_bf16 v[64:67], v[120:123], v[96:99], v[64:67]
    v_mfma_f32_16x16x32_bf16 v[84:87], v[120:123], v[100:103], v[84:87]
    s_waitcnt vmcnt(18)
    v_mfma_f32_16x16x32_bf16 v[8:11], v[140:143], v[124:127], v[8:11]
    v_mfma_f32_16x16x32_bf16 v[28:31], v[140:143], v[128:131], v[28:31]
    v_mfma_f32_16x16x32_bf16 v[48:51], v[140:143], v[132:135], v[48:51]
    v_mfma_f32_16x16x32_bf16 v[68:71], v[140:143], v[136:139], v[68:71]
    s_lshl_b32 s45, s26, 6
    s_lshl_b32 s46, s24, 4
    s_add_u32 s45, s45, s46
    v_add_u32 v6, s45, v2
    v_lshlrev_b32 v7, 3, v6
    v_add_u32 v7, 13500416, v7
    v_mul_u32_u24 v6, 1280, v6
    s_mul_i32 s47, s25, 160
    v_lshlrev_b32 v232, 3, v3
    v_add_u32 v232, s47, v232
    v_add_u32 v6, v6, v232
    buffer_load_dwordx2 v[88:89], v6, s[8:11], 0 offen offset:0
    buffer_load_dwordx2 v[90:91], v6, s[8:11], 0 offen offset:32
    buffer_load_dwordx2 v[92:93], v6, s[8:11], 0 offen offset:64
    buffer_load_dwordx2 v[94:95], v6, s[8:11], 0 offen offset:96
    buffer_load_dwordx2 v[96:97], v6, s[8:11], 0 offen offset:128
    buffer_load_dwordx2 v[98:99], v232, s[12:15], 0 offen offset:0
    buffer_load_dwordx2 v[100:101], v232, s[12:15], 0 offen offset:32
    buffer_load_dwordx2 v[102:103], v232, s[12:15], 0 offen offset:64
    buffer_load_dwordx2 v[104:105], v232, s[12:15], 0 offen offset:96
    buffer_load_dwordx2 v[106:107], v232, s[12:15], 0 offen offset:128
    buffer_load_dwordx2 v[108:109], v7, s[16:19], 0 offen
    v_mfma_f32_16x16x32_bf16 v[12:15], v[144:147], v[124:127], v[12:15]
    v_mfma_f32_16x16x32_bf16 v[32:35], v[144:147], v[128:131], v[32:35]
    v_mfma_f32_16x16x32_bf16 v[52:55], v[144:147], v[132:135], v[52:55]
    v_mfma_f32_16x16x32_bf16 v[72:75], v[144:147], v[136:139], v[72:75]
    v_mfma_f32_16x16x32_bf16 v[16:19], v[148:151], v[124:127], v[16:19]
    v_mfma_f32_16x16x32_bf16 v[36:39], v[148:151], v[128:131], v[36:39]
    v_mfma_f32_16x16x32_bf16 v[56:59], v[148:151], v[132:135], v[56:59]
    v_mfma_f32_16x16x32_bf16 v[76:79], v[148:151], v[136:139], v[76:79]
    v_mfma_f32_16x16x32_bf16 v[20:23], v[152:155], v[124:127], v[20:23]
    v_mfma_f32_16x16x32_bf16 v[40:43], v[152:155], v[128:131], v[40:43]
    v_mfma_f32_16x16x32_bf16 v[60:63], v[152:155], v[132:135], v[60:63]
    v_mfma_f32_16x16x32_bf16 v[80:83], v[152:155], v[136:139], v[80:83]
    v_mfma_f32_16x16x32_bf16 v[24:27], v[156:159], v[124:127], v[24:27]
    v_mfma_f32_16x16x32_bf16 v[44:47], v[156:159], v[128:131], v[44:47]
    v_mfma_f32_16x16x32_bf16 v[64:67], v[156:159], v[132:135], v[64:67]
    v_mfma_f32_16x16x32_bf16 v[84:87], v[156:159], v[136:139], v[84:87]
    s_waitcnt vmcnt(20)
    v_mfma_f32_16x16x32_bf16 v[8:11], v[176:179], v[160:163], v[8:11]
    v_mfma_f32_16x16x32_bf16 v[28:31], v[176:179], v[164:167], v[28:31]
    v_mfma_f32_16x16x32_bf16 v[48:51], v[176:179], v[168:171], v[48:51]
    v_mfma_f32_16x16x32_bf16 v[68:71], v[176:179], v[172:175], v[68:71]
    v_mfma_f32_16x16x32_bf16 v[12:15], v[180:183], v[160:163], v[12:15]
    v_mfma_f32_16x16x32_bf16 v[32:35], v[180:183], v[164:167], v[32:35]
    v_mfma_f32_16x16x32_bf16 v[52:55], v[180:183], v[168:171], v[52:55]
    v_mfma_f32_16x16x32_bf16 v[72:75], v[180:183], v[172:175], v[72:75]
    v_mfma_f32_16x16x32_bf16 v[16:19], v[184:187], v[160:163], v[16:19]
    v_mfma_f32_16x16x32_bf16 v[36:39], v[184:187], v[164:167], v[36:39]
    v_mfma_f32_16x16x32_bf16 v[56:59], v[184:187], v[168:171], v[56:59]
    v_mfma_f32_16x16x32_bf16 v[76:79], v[184:187], v[172:175], v[76:79]
    v_mfma_f32_16x16x32_bf16 v[20:23], v[188:191], v[160:163], v[20:23]
    v_mfma_f32_16x16x32_bf16 v[40:43], v[188:191], v[164:167], v[40:43]
    v_mfma_f32_16x16x32_bf16 v[60:63], v[188:191], v[168:171], v[60:63]
    v_mfma_f32_16x16x32_bf16 v[80:83], v[188:191], v[172:175], v[80:83]
    v_mfma_f32_16x16x32_bf16 v[24:27], v[192:195], v[160:163], v[24:27]
    v_mfma_f32_16x16x32_bf16 v[44:47], v[192:195], v[164:167], v[44:47]
    v_mfma_f32_16x16x32_bf16 v[64:67], v[192:195], v[168:171], v[64:67]
    v_mfma_f32_16x16x32_bf16 v[84:87], v[192:195], v[172:175], v[84:87]
    s_waitcnt vmcnt(11)
    v_mfma_f32_16x16x32_bf16 v[8:11], v[212:215], v[196:199], v[8:11]
    v_mfma_f32_16x16x32_bf16 v[28:31], v[212:215], v[200:203], v[28:31]
    v_mfma_f32_16x16x32_bf16 v[48:51], v[212:215], v[204:207], v[48:51]
    v_mfma_f32_16x16x32_bf16 v[68:71], v[212:215], v[208:211], v[68:71]
    v_mfma_f32_16x16x32_bf16 v[12:15], v[216:219], v[196:199], v[12:15]
    v_mfma_f32_16x16x32_bf16 v[32:35], v[216:219], v[200:203], v[32:35]
    v_mfma_f32_16x16x32_bf16 v[52:55], v[216:219], v[204:207], v[52:55]
    v_mfma_f32_16x16x32_bf16 v[72:75], v[216:219], v[208:211], v[72:75]
    v_mfma_f32_16x16x32_bf16 v[16:19], v[220:223], v[196:199], v[16:19]
    v_mfma_f32_16x16x32_bf16 v[36:39], v[220:223], v[200:203], v[36:39]
    v_mfma_f32_16x16x32_bf16 v[56:59], v[220:223], v[204:207], v[56:59]
    v_mfma_f32_16x16x32_bf16 v[76:79], v[220:223], v[208:211], v[76:79]
    v_mfma_f32_16x16x32_bf16 v[20:23], v[224:227], v[196:199], v[20:23]
    v_mfma_f32_16x16x32_bf16 v[40:43], v[224:227], v[200:203], v[40:43]
    v_mfma_f32_16x16x32_bf16 v[60:63], v[224:227], v[204:207], v[60:63]
    v_mfma_f32_16x16x32_bf16 v[80:83], v[224:227], v[208:211], v[80:83]
    v_mfma_f32_16x16x32_bf16 v[24:27], v[228:231], v[196:199], v[24:27]
    v_mfma_f32_16x16x32_bf16 v[44:47], v[228:231], v[200:203], v[44:47]
    v_mfma_f32_16x16x32_bf16 v[64:67], v[228:231], v[204:207], v[64:67]
    v_mfma_f32_16x16x32_bf16 v[84:87], v[228:231], v[208:211], v[84:87]
    s_nop 4
    v_mov_b32 v249, 115072
B_xfree:
    ds_read_b128 v[244:247], v249
    s_waitcnt lgkmcnt(0)
    v_min3_u32 v244, v244, v245, v246
    v_min_u32 v244, v244, v247
    v_cmp_gt_u32 vcc, 13, v244
    s_nop 1
    s_cbranch_vccz B_xfree_ok
    s_sleep 1
    s_branch B_xfree
B_xfree_ok:
    s_add_u32 s29, s24, 1
    s_and_b32 s29, s29, 3
    s_mul_i32 s29, s29, 15360
    s_add_u32 s29, s29, 0
    v_add_u32 v233, s29, v4
    ds_write_b128 v233, v[28:31] offset:0
    ds_write_b128 v233, v[32:35] offset:1024
    ds_write_b128 v233, v[36:39] offset:2048
    ds_write_b128 v233, v[40:43] offset:3072
    ds_write_b128 v233, v[44:47] offset:4096
    s_add_u32 s29, s24, 2
    s_and_b32 s29, s29, 3
    s_mul_i32 s29, s29, 15360
    s_add_u32 s29, s29, 5120
    v_add_u32 v233, s29, v4
    ds_write_b128 v233, v[48:51] offset:0
    ds_write_b128 v233, v[52:55] offset:1024
    ds_write_b128 v233, v[56:59] offset:2048
    ds_write_b128 v233, v[60:63] offset:3072
    ds_write_b128 v233, v[64:67] offset:4096
    s_add_u32 s29, s24, 3
    s_and_b32 s29, s29, 3
    s_mul_i32 s29, s29, 15360
    s_add_u32 s29, s29, 10240
    v_add_u32 v233, s29, v4
    ds_write_b128 v233, v[68:71] offset:0
    ds_write_b128 v233, v[72:75] offset:1024
    ds_write_b128 v233, v[76:79] offset:2048
    ds_write_b128 v233, v[80:83] offset:3072
    ds_write_b128 v233, v[84:87] offset:4096
    s_mul_i32 s29, s24, 15360
    s_add_u32 s29, s29, 0
    v_add_u32 v233, s29, v4
    v_bfe_u32 v234, v1, 2, 2
    v_lshlrev_b32 v235, 2, v3
    v_add_u32 v234, v234, v235
    v_lshlrev_b32 v234, 7, v234
    v_and_b32 v235, 3, v1
    v_lshlrev_b32 v235, 3, v235
    v_add_u32 v234, v234, v235
    s_lshl_b32 s29, s24, 5
    s_add_u32 s29, s29, 102400
    v_add_u32 v234, s29, v234
    s_waitcnt lgkmcnt(0)
    s_lshl_b32 s29, s24, 2
    s_add_u32 s29, s29, 115072
    v_mov_b32 v248, s29
    v_mov_b32 v250, 14
    v_mov_b32 v249, 115072
    s_mov_b64 exec, 1
    ds_write_b32 v248, v250
    s_mov_b64 exec, -1
B_xw:
    ds_read_b128 v[244:247], v249
    ds_read_b32 v251, v249 offset:36
    s_waitcnt lgkmcnt(0)
    v_min3_u32 v244, v244, v245, v246
    v_min3_u32 v244, v244, v247, v251
    v_cmp_gt_u32 vcc, 14, v244
    s_nop 1
    s_cbranch_vccnz B_xw
    ds_read_b128 v[112:115], v233 offset:0
    ds_read_b128 v[116:119], v233 offset:1024
    ds_read_b128 v[120:123], v233 offset:2048
    ds_read_b128 v[124:127], v233 offset:3072
    ds_read_b128 v[128:131], v233 offset:4096
    ds_read_b128 v[132:135], v233 offset:5120
    ds_read_b128 v[136:139], v233 offset:6144
    ds_read_b128 v[140:143], v233 offset:7168
    ds_read_b128 v[144:147], v233 offset:8192
    ds_read_b128 v[148:151], v233 offset:9216
    s_waitcnt lgkmcnt(5)
    v_add_f32 v8, v8, v112
    v_add_f32 v9, v9, v113
    v_add_f32 v10, v10, v114
    v_add_f32 v11, v11, v115
    v_add_f32 v12, v12, v116
    v_add_f32 v13, v13, v117
    v_add_f32 v14, v14, v118
    v_add_f32 v15, v15, v119
    v_add_f32 v16, v16, v120
    v_add_f32 v17, v17, v121
    v_add_f32 v18, v18, v122
    v_add_f32 v19, v19, v123
    v_add_f32 v20, v20, v124
    v_add_f32 v21, v21, v125
    v_add_f32 v22, v22, v126
    v_add_f32 v23, v23, v127
    v_add_f32 v24, v24, v128
    v_add_f32 v25, v25, v129
    v_add_f32 v26, v26, v130
    v_add_f32 v27, v27, v131
    ds_read_b128 v[152:155], v233 offset:10240
    ds_read_b128 v[156:159], v233 offset:11264
    ds_read_b128 v[160:163], v233 offset:12288
    ds_read_b128 v[164:167], v233 offset:13312
    ds_read_b128 v[168:171], v233 offset:14336
    ds_read_b64_tr_b16 v[172:173], v234 offset:0
    ds_read_b64_tr_b16 v[174:175], v234 offset:2048
    ds_read_b64_tr_b16 v[176:177], v234 offset:4096
    ds_read_b64_tr_b16 v[178:179], v234 offset:6144
    ds_read_b64_tr_b16 v[180:181], v234 offset:8192
    s_waitcnt lgkmcnt(10)
    v_add_f32 v8, v8, v132
    v_add_f32 v9, v9, v133
    v_add_f32 v10, v10, v134
    v_add_f32 v11, v11, v135
    v_add_f32 v12, v12, v136
    v_add_f32 v13, v13, v137
    v_add_f32 v14, v14, v138
    v_add_f32 v15, v15, v139
    v_add_f32 v16, v16, v140
    v_add_f32 v17, v17, v141
    v_add_f32 v18, v18, v142
    v_add_f32 v19, v19, v143
    v_add_f32 v20, v20, v144
    v_add_f32 v21, v21, v145
    v_add_f32 v22, v22, v146
    v_add_f32 v23, v23, v147
    v_add_f32 v24, v24, v148
    v_add_f32 v25, v25, v149
    v_add_f32 v26, v26, v150
    v_add_f32 v27, v27, v151
    s_waitcnt lgkmcnt(5)
    v_add_f32 v8, v8, v152
    v_add_f32 v9, v9, v153
    v_add_f32 v10, v10, v154
    v_add_f32 v11, v11, v155
    v_add_f32 v12, v12, v156
    v_add_f32 v13, v13, v157
    v_add_f32 v14, v14, v158
    v_add_f32 v15, v15, v159
    v_add_f32 v16, v16, v160
    v_add_f32 v17, v17, v161
    v_add_f32 v18, v18, v162
    v_add_f32 v19, v19, v163
    v_add_f32 v20, v20, v164
    v_add_f32 v21, v21, v165
    v_add_f32 v22, v22, v166
    v_add_f32 v23, v23, v167
    v_add_f32 v24, v24, v168
    v_add_f32 v25, v25, v169
    v_add_f32 v26, v26, v170
    v_add_f32 v27, v27, v171
    s_waitcnt vmcnt(0) lgkmcnt(0)
    v_lshlrev_b32 v112, 16, v88
    v_and_b32 v113, 0xffff0000, v88
    v_lshlrev_b32 v116, 16, v172
    v_and_b32 v117, 0xffff0000, v172
    v_lshlrev_b32 v120, 16, v98
    v_and_b32 v121, 0xffff0000, v98
    v_lshlrev_b32 v114, 16, v89
    v_and_b32 v115, 0xffff0000, v89
    v_lshlrev_b32 v118, 16, v173
    v_and_b32 v119, 0xffff0000, v173
    v_lshlrev_b32 v122, 16, v99
    v_and_b32 v123, 0xffff0000, v99
    v_add_f32 v8, v8, v120
    v_add_f32 v8, v8, v112
    v_sub_f32 v112, v112, v108
    v_mul_f32 v112, v112, v109
    v_add_f32 v9, v9, v121
    v_add_f32 v9, v9, v113
    v_sub_f32 v113, v113, v108
    v_mul_f32 v113, v113, v109
    v_add_f32 v10, v10, v122
    v_add_f32 v10, v10, v114
    v_sub_f32 v114, v114, v108
    v_mul_f32 v114, v114, v109
    v_add_f32 v11, v11, v123
    v_add_f32 v11, v11, v115
    v_sub_f32 v115, v115, v108
    v_mul_f32 v115, v115, v109
    v_cvt_pk_bf16_f32 v112, v112, v113
    v_cvt_pk_bf16_f32 v114, v114, v115
    v_and_b32 v113, 0xffff0000, v112
    v_lshlrev_b32 v112, 16, v112
    v_and_b32 v115, 0xffff0000, v114
    v_lshlrev_b32 v114, 16, v114
    v_fma_f32 v8, v112, v116, v8
    v_fma_f32 v9, v113, v117, v9
    v_fma_f32 v10, v114, v118, v10
    v_fma_f32 v11, v115, v119, v11
    v_cvt_pk_bf16_f32 v128, v8, v9
    v_cvt_pk_bf16_f32 v129, v10, v11
    buffer_store_dwordx2 v[128:129], v6, s[20:23], 0 offen offset:0
    v_lshlrev_b32 v112, 16, v90
    v_and_b32 v113, 0xffff0000, v90
    v_lshlrev_b32 v116, 16, v174
    v_and_b32 v117, 0xffff0000, v174
    v_lshlrev_b32 v120, 16, v100
    v_and_b32 v121, 0xffff0000, v100
    v_lshlrev_b32 v114, 16, v91
    v_and_b32 v115, 0xffff0000, v91
    v_lshlrev_b32 v118, 16, v175
    v_and_b32 v119, 0xffff0000, v175
    v_lshlrev_b32 v122, 16, v101
    v_and_b32 v123, 0xffff0000, v101
    v_add_f32 v12, v12, v120
    v_add_f32 v12, v12, v112
    v_sub_f32 v112, v112, v108
    v_mul_f32 v112, v112, v109
    v_add_f32 v13, v13, v121
    v_add_f32 v13, v13, v113
    v_sub_f32 v113, v113, v108
    v_mul_f32 v113, v113, v109
    v_add_f32 v14, v14, v122
    v_add_f32 v14, v14, v114
    v_sub_f32 v114, v114, v108
    v_mul_f32 v114, v114, v109
    v_add_f32 v15, v15, v123
    v_add_f32 v15, v15, v115
    v_sub_f32 v115, v115, v108
    v_mul_f32 v115, v115, v109
    v_cvt_pk_bf16_f32 v112, v112, v113
    v_cvt_pk_bf16_f32 v114, v114, v115
    v_and_b32 v113, 0xffff0000, v112
    v_lshlrev_b32 v112, 16, v112
    v_and_b32 v115, 0xffff0000, v114
    v_lshlrev_b32 v114, 16, v114
    v_fma_f32 v12, v112, v116, v12
    v_fma_f32 v13, v113, v117, v13
    v_fma_f32 v14, v114, v118, v14
    v_fma_f32 v15, v115, v119, v15
    v_cvt_pk_bf16_f32 v130, v12, v13
    v_cvt_pk_bf16_f32 v131, v14, v15
    buffer_store_dwordx2 v[130:131], v6, s[20:23], 0 offen offset:32
    v_lshlrev_b32 v112, 16, v92
    v_and_b32 v113, 0xffff0000, v92
    v_lshlrev_b32 v116, 16, v176
    v_and_b32 v117, 0xffff0000, v176
    v_lshlrev_b32 v120, 16, v102
    v_and_b32 v121, 0xffff0000, v102
    v_lshlrev_b32 v114, 16, v93
    v_and_b32 v115, 0xffff0000, v93
    v_lshlrev_b32 v118, 16, v177
    v_and_b32 v119, 0xffff0000, v177
    v_lshlrev_b32 v122, 16, v103
    v_and_b32 v123, 0xffff0000, v103
    v_add_f32 v16, v16, v120
    v_add_f32 v16, v16, v112
    v_sub_f32 v112, v112, v108
    v_mul_f32 v112, v112, v109
    v_add_f32 v17, v17, v121
    v_add_f32 v17, v17, v113
    v_sub_f32 v113, v113, v108
    v_mul_f32 v113, v113, v109
    v_add_f32 v18, v18, v122
    v_add_f32 v18, v18, v114
    v_sub_f32 v114, v114, v108
    v_mul_f32 v114, v114, v109
    v_add_f32 v19, v19, v123
    v_add_f32 v19, v19, v115
    v_sub_f32 v115, v115, v108
    v_mul_f32 v115, v115, v109
    v_cvt_pk_bf16_f32 v112, v112, v113
    v_cvt_pk_bf16_f32 v114, v114, v115
    v_and_b32 v113, 0xffff0000, v112
    v_lshlrev_b32 v112, 16, v112
    v_and_b32 v115, 0xffff0000, v114
    v_lshlrev_b32 v114, 16, v114
    v_fma_f32 v16, v112, v116, v16
    v_fma_f32 v17, v113, v117, v17
    v_fma_f32 v18, v114, v118, v18
    v_fma_f32 v19, v115, v119, v19
    v_cvt_pk_bf16_f32 v132, v16, v17
    v_cvt_pk_bf16_f32 v133, v18, v19
    buffer_store_dwordx2 v[132:133], v6, s[20:23], 0 offen offset:64
    v_lshlrev_b32 v112, 16, v94
    v_and_b32 v113, 0xffff0000, v94
    v_lshlrev_b32 v116, 16, v178
    v_and_b32 v117, 0xffff0000, v178
    v_lshlrev_b32 v120, 16, v104
    v_and_b32 v121, 0xffff0000, v104
    v_lshlrev_b32 v114, 16, v95
    v_and_b32 v115, 0xffff0000, v95
    v_lshlrev_b32 v118, 16, v179
    v_and_b32 v119, 0xffff0000, v179
    v_lshlrev_b32 v122, 16, v105
    v_and_b32 v123, 0xffff0000, v105
    v_add_f32 v20, v20, v120
    v_add_f32 v20, v20, v112
    v_sub_f32 v112, v112, v108
    v_mul_f32 v112, v112, v109
    v_add_f32 v21, v21, v121
    v_add_f32 v21, v21, v113
    v_sub_f32 v113, v113, v108
    v_mul_f32 v113, v113, v109
    v_add_f32 v22, v22, v122
    v_add_f32 v22, v22, v114
    v_sub_f32 v114, v114, v108
    v_mul_f32 v114, v114, v109
    v_add_f32 v23, v23, v123
    v_add_f32 v23, v23, v115
    v_sub_f32 v115, v115, v108
    v_mul_f32 v115, v115, v109
    v_cvt_pk_bf16_f32 v112, v112, v113
    v_cvt_pk_bf16_f32 v114, v114, v115
    v_and_b32 v113, 0xffff0000, v112
    v_lshlrev_b32 v112, 16, v112
    v_and_b32 v115, 0xffff0000, v114
    v_lshlrev_b32 v114, 16, v114
    v_fma_f32 v20, v112, v116, v20
    v_fma_f32 v21, v113, v117, v21
    v_fma_f32 v22, v114, v118, v22
    v_fma_f32 v23, v115, v119, v23
    v_cvt_pk_bf16_f32 v134, v20, v21
    v_cvt_pk_bf16_f32 v135, v22, v23
    buffer_store_dwordx2 v[134:135], v6, s[20:23], 0 offen offset:96
    v_lshlrev_b32 v112, 16, v96
    v_and_b32 v113, 0xffff0000, v96
    v_lshlrev_b32 v116, 16, v180
    v_and_b32 v117, 0xffff0000, v180
    v_lshlrev_b32 v120, 16, v106
    v_and_b32 v121, 0xffff0000, v106
    v_lshlrev_b32 v114, 16, v97
    v_and_b32 v115, 0xffff0000, v97
    v_lshlrev_b32 v118, 16, v181
    v_and_b32 v119, 0xffff0000, v181
    v_lshlrev_b32 v122, 16, v107
    v_and_b32 v123, 0xffff0000, v107
    v_add_f32 v24, v24, v120
    v_add_f32 v24, v24, v112
    v_sub_f32 v112, v112, v108
    v_mul_f32 v112, v112, v109
    v_add_f32 v25, v25, v121
    v_add_f32 v25, v25, v113
    v_sub_f32 v113, v113, v108
    v_mul_f32 v113, v113, v109
    v_add_f32 v26, v26, v122
    v_add_f32 v26, v26, v114
    v_sub_f32 v114, v114, v108
    v_mul_f32 v114, v114, v109
    v_add_f32 v27, v27, v123
    v_add_f32 v27, v27, v115
    v_sub_f32 v115, v115, v108
    v_mul_f32 v115, v115, v109
    v_cvt_pk_bf16_f32 v112, v112, v113
    v_cvt_pk_bf16_f32 v114, v114, v115
    v_and_b32 v113, 0xffff0000, v112
    v_lshlrev_b32 v112, 16, v112
    v_and_b32 v115, 0xffff0000, v114
    v_lshlrev_b32 v114, 16, v114
    v_fma_f32 v24, v112, v116, v24
    v_fma_f32 v25, v113, v117, v25
    v_fma_f32 v26, v114, v118, v26
    v_fma_f32 v27, v115, v119, v27
    v_cvt_pk_bf16_f32 v136, v24, v25
    v_cvt_pk_bf16_f32 v137, v26, v27
    buffer_store_dwordx2 v[136:137], v6, s[20:23], 0 offen offset:128
    s_endpgm
A_prep:
    s_lshl_b32 s25, s2, 2
    s_add_u32 s25, s25, s24
    s_sub_u32 s25, s25, 4
    s_sub_u32 s26, s24, 4
    s_mul_i32 s26, s26, 12928
    s_add_u32 s26, s26, 115200
    s_load_dwordx2 s[34:35], s[0:1], 104
    s_cmp_ge_u32 s25, 640
    s_cbranch_scc1 A_w2prep
    s_load_dwordx2 s[4:5], s[0:1], 8
    s_load_dwordx2 s[6:7], s[0:1], 16
    s_load_dwordx2 s[32:33], s[0:1], 24
    s_lshr_b32 s28, s2, 4
    s_and_b32 s27, s2, 15
    s_lshl_b32 s27, s27, 2
    s_add_u32 s27, s27, s24
    s_sub_u32 s27, s27, 4
    v_lshrrev_b32 v4, 3, v1
    v_and_b32 v5, 7, v1
    s_lshl_b32 s29, s27, 5
    v_lshlrev_b32 v6, 2, v4
    v_add_u32 v6, s29, v6
    v_mul_u32_u24 v6, 1280, v6
    s_lshl_b32 s30, s28, 7
    v_lshlrev_b32 v7, 4, v5
    v_add_u32 v7, s30, v7
    v_add_u32 v6, v6, v7
    v_lshlrev_b32 v8, 2, v7
    s_waitcnt lgkmcnt(0)
    s_mov_b32 s8, s4
    s_mov_b32 s9, s5
    s_mov_b32 s10, 2621440
    s_mov_b32 s11, 0x00020000
    s_mov_b32 s12, s6
    s_mov_b32 s13, s7
    s_mov_b32 s14, 2621440
    s_mov_b32 s15, 0x00020000
    s_mov_b32 s20, s32
    s_mov_b32 s21, s33
    s_mov_b32 s22, 5120
    s_mov_b32 s23, 0x00020000
    s_mov_b32 s16, s34
    s_mov_b32 s17, s35
    s_mov_b32 s18, 13680640
    s_mov_b32 s19, 0x00020000
    v_add_u32 v9, 4294963456, v6
    buffer_load_dwordx4 v[16:19], v9, s[8:11], 0 offen
    v_add_u32 v9, 4294964736, v6
    buffer_load_dwordx4 v[20:23], v9, s[8:11], 0 offen
    v_add_u32 v9, 4294966016, v6
    buffer_load_dwordx4 v[24:27], v9, s[8:11], 0 offen
    v_add_u32 v9, 0, v6
    buffer_load_dwordx4 v[28:31], v9, s[8:11], 0 offen
    v_add_u32 v9, 1280, v6
    buffer_load_dwordx4 v[32:35], v9, s[8:11], 0 offen
    v_add_u32 v9, 2560, v6
    buffer_load_dwordx4 v[36:39], v9, s[8:11], 0 offen
    v_add_u32 v9, 3840, v6
    buffer_load_dwordx4 v[40:43], v9, s[8:11], 0 offen
    buffer_load_dwordx4 v[44:47], v6, s[12:15], 0 offen offset:0
    buffer_load_dwordx4 v[48:51], v6, s[12:15], 0 offen offset:1280
    buffer_load_dwordx4 v[52:55], v6, s[12:15], 0 offen offset:2560
    buffer_load_dwordx4 v[56:59], v6, s[12:15], 0 offen offset:3840
    buffer_load_dwordx4 v[60:63], v8, s[20:23], 0 offen offset:0
    buffer_load_dwordx4 v[64:67], v8, s[20:23], 0 offen offset:16
    buffer_load_dwordx4 v[68:71], v8, s[20:23], 0 offen offset:32
    buffer_load_dwordx4 v[72:75], v8, s[20:23], 0 offen offset:48
    s_load_dwordx2 s[6:7], s[0:1], 96
    s_cmp_lg_u32 s25, 3
    s_cbranch_scc1 A_noclr
    v_lshlrev_b32 v9, 7, v1
    v_mov_b32 v10, 0
    v_mov_b32 v11, 0
    v_mov_b32 v12, 0
    v_mov_b32 v13, 0
    s_mov_b32 s38, 13516800
    buffer_store_dwordx4 v[10:13], v9, s[16:19], s38 offen sc1
    s_add_u32 s38, s38, 8192
    buffer_store_dwordx4 v[10:13], v9, s[16:19], s38 offen sc1
    s_add_u32 s38, s38, 8192
    buffer_store_dwordx4 v[10:13], v9, s[16:19], s38 offen sc1
    s_add_u32 s38, s38, 8192
    buffer_store_dwordx4 v[10:13], v9, s[16:19], s38 offen sc1
A_noclr:
    s_waitcnt lgkmcnt(0)
    s_mov_b32 s40, s6
    s_mov_b32 s41, s7
    s_mov_b32 s42, 256
    s_mov_b32 s43, 0x00020000
    s_barrier
    s_waitcnt vmcnt(0)
    s_cmp_lg_u32 s25, 3
    s_cbranch_scc1 A_noann
    v_mov_b32 v9, 0
    v_mov_b32 v10, 1
    s_mov_b64 exec, 1
    buffer_store_dword v10, v9, s[40:43], 0 offen sc1
    s_mov_b64 exec, -1
A_noann:
    v_lshlrev_b32 v80, 16, v16
    v_and_b32 v81, 0xffff0000, v16
    v_lshlrev_b32 v82, 16, v17
    v_and_b32 v83, 0xffff0000, v17
    v_lshlrev_b32 v84, 16, v18
    v_and_b32 v85, 0xffff0000, v18
    v_lshlrev_b32 v86, 16, v19
    v_and_b32 v87, 0xffff0000, v19
    v_lshlrev_b32 v88, 16, v20
    v_and_b32 v89, 0xffff0000, v20
    v_lshlrev_b32 v90, 16, v21
    v_and_b32 v91, 0xffff0000, v21
    v_lshlrev_b32 v92, 16, v22
    v_and_b32 v93, 0xffff0000, v22
    v_lshlrev_b32 v94, 16, v23
    v_and_b32 v95, 0xffff0000, v23
    v_lshlrev_b32 v96, 16, v24
    v_and_b32 v97, 0xffff0000, v24
    v_lshlrev_b32 v98, 16, v25
    v_and_b32 v99, 0xffff0000, v25
    v_lshlrev_b32 v100, 16, v26
    v_and_b32 v101, 0xffff0000, v26
    v_lshlrev_b32 v102, 16, v27
    v_and_b32 v103, 0xffff0000, v27
    v_lshlrev_b32 v104, 16, v28
    v_and_b32 v105, 0xffff0000, v28
    v_lshlrev_b32 v106, 16, v29
    v_and_b32 v107, 0xffff0000, v29
    v_lshlrev_b32 v108, 16, v30
    v_and_b32 v109, 0xffff0000, v30
    v_lshlrev_b32 v110, 16, v31
    v_and_b32 v111, 0xffff0000, v31
    v_lshlrev_b32 v112, 16, v32
    v_and_b32 v113, 0xffff0000, v32
    v_lshlrev_b32 v114, 16, v33
    v_and_b32 v115, 0xffff0000, v33
    v_lshlrev_b32 v116, 16, v34
    v_and_b32 v117, 0xffff0000, v34
    v_lshlrev_b32 v118, 16, v35
    v_and_b32 v119, 0xffff0000, v35
    v_lshlrev_b32 v120, 16, v36
    v_and_b32 v121, 0xffff0000, v36
    v_lshlrev_b32 v122, 16, v37
    v_and_b32 v123, 0xffff0000, v37
    v_lshlrev_b32 v124, 16, v38
    v_and_b32 v125, 0xffff0000, v38
    v_lshlrev_b32 v126, 16, v39
    v_and_b32 v127, 0xffff0000, v39
    v_lshlrev_b32 v128, 16, v40
    v_and_b32 v129, 0xffff0000, v40
    v_lshlrev_b32 v130, 16, v41
    v_and_b32 v131, 0xffff0000, v41
    v_lshlrev_b32 v132, 16, v42
    v_and_b32 v133, 0xffff0000, v42
    v_lshlrev_b32 v134, 16, v43
    v_and_b32 v135, 0xffff0000, v43
    v_lshlrev_b32 v136, 16, v60
    v_and_b32 v137, 0xffff0000, v60
    v_lshlrev_b32 v138, 16, v61
    v_and_b32 v139, 0xffff0000, v61
    v_lshlrev_b32 v140, 16, v62
    v_and_b32 v141, 0xffff0000, v62
    v_lshlrev_b32 v142, 16, v63
    v_and_b32 v143, 0xffff0000, v63
    v_lshlrev_b32 v144, 16, v64
    v_and_b32 v145, 0xffff0000, v64
    v_lshlrev_b32 v146, 16, v65
    v_and_b32 v147, 0xffff0000, v65
    v_lshlrev_b32 v148, 16, v66
    v_and_b32 v149, 0xffff0000, v66
    v_lshlrev_b32 v150, 16, v67
    v_and_b32 v151, 0xffff0000, v67
    v_lshlrev_b32 v152, 16, v68
    v_and_b32 v153, 0xffff0000, v68
    v_lshlrev_b32 v154, 16, v69
    v_and_b32 v155, 0xffff0000, v69
    v_lshlrev_b32 v156, 16, v70
    v_and_b32 v157, 0xffff0000, v70
    v_lshlrev_b32 v158, 16, v71
    v_and_b32 v159, 0xffff0000, v71
    v_lshlrev_b32 v160, 16, v72
    v_and_b32 v161, 0xffff0000, v72
    v_lshlrev_b32 v162, 16, v73
    v_and_b32 v163, 0xffff0000, v73
    v_lshlrev_b32 v164, 16, v74
    v_and_b32 v165, 0xffff0000, v74
    v_lshlrev_b32 v166, 16, v75
    v_and_b32 v167, 0xffff0000, v75
    v_lshlrev_b32 v168, 16, v44
    v_and_b32 v169, 0xffff0000, v44
    v_lshlrev_b32 v170, 16, v45
    v_and_b32 v171, 0xffff0000, v45
    v_lshlrev_b32 v172, 16, v46
    v_and_b32 v173, 0xffff0000, v46
    v_lshlrev_b32 v174, 16, v47
    v_and_b32 v175, 0xffff0000, v47
    v_lshlrev_b32 v176, 16, v48
    v_and_b32 v177, 0xffff0000, v48
    v_lshlrev_b32 v178, 16, v49
    v_and_b32 v179, 0xffff0000, v49
    v_lshlrev_b32 v180, 16, v50
    v_and_b32 v181, 0xffff0000, v50
    v_lshlrev_b32 v182, 16, v51
    v_and_b32 v183, 0xffff0000, v51
    v_lshlrev_b32 v184, 16, v52
    v_and_b32 v185, 0xffff0000, v52
    v_lshlrev_b32 v186, 16, v53
    v_and_b32 v187, 0xffff0000, v53
    v_lshlrev_b32 v188, 16, v54
    v_and_b32 v189, 0xffff0000, v54
    v_lshlrev_b32 v190, 16, v55
    v_and_b32 v191, 0xffff0000, v55
    v_lshlrev_b32 v192, 16, v56
    v_and_b32 v193, 0xffff0000, v56
    v_lshlrev_b32 v194, 16, v57
    v_and_b32 v195, 0xffff0000, v57
    v_lshlrev_b32 v196, 16, v58
    v_and_b32 v197, 0xffff0000, v58
    v_lshlrev_b32 v198, 16, v59
    v_and_b32 v199, 0xffff0000, v59
    v_mul_f32 v200, v104, v136
    v_mul_f32 v201, v105, v140
    v_mul_f32 v202, v106, v144
    v_mul_f32 v203, v107, v148
    v_mul_f32 v204, v108, v152
    v_mul_f32 v205, v109, v156
    v_mul_f32 v206, v110, v160
    v_mul_f32 v207, v111, v164
    v_fma_f32 v200, v96, v137, v200
    v_fma_f32 v201, v97, v141, v201
    v_fma_f32 v202, v98, v145, v202
    v_fma_f32 v203, v99, v149, v203
    v_fma_f32 v204, v100, v153, v204
    v_fma_f32 v205, v101, v157, v205
    v_fma_f32 v206, v102, v161, v206
    v_fma_f32 v207, v103, v165, v207
    v_fma_f32 v200, v88, v138, v200
    v_fma_f32 v201, v89, v142, v201
    v_fma_f32 v202, v90, v146, v202
    v_fma_f32 v203, v91, v150, v203
    v_fma_f32 v204, v92, v154, v204
    v_fma_f32 v205, v93, v158, v205
    v_fma_f32 v206, v94, v162, v206
    v_fma_f32 v207, v95, v166, v207
    v_fma_f32 v200, v80, v139, v200
    v_fma_f32 v201, v81, v143, v201
    v_fma_f32 v202, v82, v147, v202
    v_fma_f32 v203, v83, v151, v203
    v_fma_f32 v204, v84, v155, v204
    v_fma_f32 v205, v85, v159, v205
    v_fma_f32 v206, v86, v163, v206
    v_fma_f32 v207, v87, v167, v207
    v_mul_f32 v200, v200, v168
    v_mul_f32 v201, v201, v169
    v_mul_f32 v202, v202, v170
    v_mul_f32 v203, v203, v171
    v_mul_f32 v204, v204, v172
    v_mul_f32 v205, v205, v173
    v_mul_f32 v206, v206, v174
    v_mul_f32 v207, v207, v175
    v_mul_f32 v208, v112, v136
    v_mul_f32 v209, v113, v140
    v_mul_f32 v210, v114, v144
    v_mul_f32 v211, v115, v148
    v_mul_f32 v212, v116, v152
    v_mul_f32 v213, v117, v156
    v_mul_f32 v214, v118, v160
    v_mul_f32 v215, v119, v164
    v_fma_f32 v208, v104, v137, v208
    v_fma_f32 v209, v105, v141, v209
    v_fma_f32 v210, v106, v145, v210
    v_fma_f32 v211, v107, v149, v211
    v_fma_f32 v212, v108, v153, v212
    v_fma_f32 v213, v109, v157, v213
    v_fma_f32 v214, v110, v161, v214
    v_fma_f32 v215, v111, v165, v215
    v_fma_f32 v208, v96, v138, v208
    v_fma_f32 v209, v97, v142, v209
    v_fma_f32 v210, v98, v146, v210
    v_fma_f32 v211, v99, v150, v211
    v_fma_f32 v212, v100, v154, v212
    v_fma_f32 v213, v101, v158, v213
    v_fma_f32 v214, v102, v162, v214
    v_fma_f32 v215, v103, v166, v215
    v_fma_f32 v208, v88, v139, v208
    v_fma_f32 v209, v89, v143, v209
    v_fma_f32 v210, v90, v147, v210
    v_fma_f32 v211, v91, v151, v211
    v_fma_f32 v212, v92, v155, v212
    v_fma_f32 v213, v93, v159, v213
    v_fma_f32 v214, v94, v163, v214
    v_fma_f32 v215, v95, v167, v215
    v_mul_f32 v208, v208, v176
    v_mul_f32 v209, v209, v177
    v_mul_f32 v210, v210, v178
    v_mul_f32 v211, v211, v179
    v_mul_f32 v212, v212, v180
    v_mul_f32 v213, v213, v181
    v_mul_f32 v214, v214, v182
    v_mul_f32 v215, v215, v183
    v_mul_f32 v216, v120, v136
    v_mul_f32 v217, v121, v140
    v_mul_f32 v218, v122, v144
    v_mul_f32 v219, v123, v148
    v_mul_f32 v220, v124, v152
    v_mul_f32 v221, v125, v156
    v_mul_f32 v222, v126, v160
    v_mul_f32 v223, v127, v164
    v_fma_f32 v216, v112, v137, v216
    v_fma_f32 v217, v113, v141, v217
    v_fma_f32 v218, v114, v145, v218
    v_fma_f32 v219, v115, v149, v219
    v_fma_f32 v220, v116, v153, v220
    v_fma_f32 v221, v117, v157, v221
    v_fma_f32 v222, v118, v161, v222
    v_fma_f32 v223, v119, v165, v223
    v_fma_f32 v216, v104, v138, v216
    v_fma_f32 v217, v105, v142, v217
    v_fma_f32 v218, v106, v146, v218
    v_fma_f32 v219, v107, v150, v219
    v_fma_f32 v220, v108, v154, v220
    v_fma_f32 v221, v109, v158, v221
    v_fma_f32 v222, v110, v162, v222
    v_fma_f32 v223, v111, v166, v223
    v_fma_f32 v216, v96, v139, v216
    v_fma_f32 v217, v97, v143, v217
    v_fma_f32 v218, v98, v147, v218
    v_fma_f32 v219, v99, v151, v219
    v_fma_f32 v220, v100, v155, v220
    v_fma_f32 v221, v101, v159, v221
    v_fma_f32 v222, v102, v163, v222
    v_fma_f32 v223, v103, v167, v223
    v_mul_f32 v216, v216, v184
    v_mul_f32 v217, v217, v185
    v_mul_f32 v218, v218, v186
    v_mul_f32 v219, v219, v187
    v_mul_f32 v220, v220, v188
    v_mul_f32 v221, v221, v189
    v_mul_f32 v222, v222, v190
    v_mul_f32 v223, v223, v191
    v_mul_f32 v224, v128, v136
    v_mul_f32 v225, v129, v140
    v_mul_f32 v226, v130, v144
    v_mul_f32 v227, v131, v148
    v_mul_f32 v228, v132, v152
    v_mul_f32 v229, v133, v156
    v_mul_f32 v230, v134, v160
    v_mul_f32 v231, v135, v164
    v_fma_f32 v224, v120, v137, v224
    v_fma_f32 v225, v121, v141, v225
    v_fma_f32 v226, v122, v145, v226
    v_fma_f32 v227, v123, v149, v227
    v_fma_f32 v228, v124, v153, v228
    v_fma_f32 v229, v125, v157, v229
    v_fma_f32 v230, v126, v161, v230
    v_fma_f32 v231, v127, v165, v231
    v_fma_f32 v224, v112, v138, v224
    v_fma_f32 v225, v113, v142, v225
    v_fma_f32 v226, v114, v146, v226
    v_fma_f32 v227, v115, v150, v227
    v_fma_f32 v228, v116, v154, v228
    v_fma_f32 v229, v117, v158, v229
    v_fma_f32 v230, v118, v162, v230
    v_fma_f32 v231, v119, v166, v231
    v_fma_f32 v224, v104, v139, v224
    v_fma_f32 v225, v105, v143, v225
    v_fma_f32 v226, v106, v147, v226
    v_fma_f32 v227, v107, v151, v227
    v_fma_f32 v228, v108, v155, v228
    v_fma_f32 v229, v109, v159, v229
    v_fma_f32 v230, v110, v163, v230
    v_fma_f32 v231, v111, v167, v231
    v_mul_f32 v224, v224, v192
    v_mul_f32 v225, v225, v193
    v_mul_f32 v226, v226, v194
    v_mul_f32 v227, v227, v195
    v_mul_f32 v228, v228, v196
    v_mul_f32 v229, v229, v197
    v_mul_f32 v230, v230, v198
    v_mul_f32 v231, v231, v199
    v_cvt_pk_bf16_f32 v232, v224, v216
    v_cvt_pk_bf16_f32 v233, v208, v200
    v_cvt_pk_bf16_f32 v234, v225, v217
    v_cvt_pk_bf16_f32 v235, v209, v201
    v_cvt_pk_bf16_f32 v236, v226, v218
    v_cvt_pk_bf16_f32 v237, v210, v202
    v_cvt_pk_bf16_f32 v238, v227, v219
    v_cvt_pk_bf16_f32 v239, v211, v203
    v_cvt_pk_bf16_f32 v240, v228, v220
    v_cvt_pk_bf16_f32 v241, v212, v204
    v_cvt_pk_bf16_f32 v242, v229, v221
    v_cvt_pk_bf16_f32 v243, v213, v205
    v_cvt_pk_bf16_f32 v244, v230, v222
    v_cvt_pk_bf16_f32 v245, v214, v206
    v_cvt_pk_bf16_f32 v246, v231, v223
    v_cvt_pk_bf16_f32 v247, v215, v207
    v_lshlrev_b32 v9, 5, v5
    v_lshrrev_b32 v10, 1, v4
    v_add_u32 v9, v9, v10
    v_and_b32 v10, 1, v4
    v_xor_b32 v10, 1, v10
    v_lshlrev_b32 v10, 3, v10
    v_add_u32 v10, s26, v10
    v_add_u32 v11, 0, v9
    v_xor_b32 v11, v11, v5
    v_lshlrev_b32 v11, 4, v11
    v_add_u32 v11, v11, v10
    ds_write_b64 v11, v[232:233]
    v_add_u32 v11, 4, v9
    v_xor_b32 v11, v11, v5
    v_lshlrev_b32 v11, 4, v11
    v_add_u32 v11, v11, v10
    ds_write_b64 v11, v[234:235]
    v_add_u32 v11, 8, v9
    v_xor_b32 v11, v11, v5
    v_lshlrev_b32 v11, 4, v11
    v_add_u32 v11, v11, v10
    ds_write_b64 v11, v[236:237]
    v_add_u32 v11, 12, v9
    v_xor_b32 v11, v11, v5
    v_lshlrev_b32 v11, 4, v11
    v_add_u32 v11, v11, v10
    ds_write_b64 v11, v[238:239]
    v_add_u32 v11, 16, v9
    v_xor_b32 v11, v11, v5
    v_lshlrev_b32 v11, 4, v11
    v_add_u32 v11, v11, v10
    ds_write_b64 v11, v[240:241]
    v_add_u32 v11, 20, v9
    v_xor_b32 v11, v11, v5
    v_lshlrev_b32 v11, 4, v11
    v_add_u32 v11, v11, v10
    ds_write_b64 v11, v[242:243]
    v_add_u32 v11, 24, v9
    v_xor_b32 v11, v11, v5
    v_lshlrev_b32 v11, 4, v11
    v_add_u32 v11, v11, v10
    ds_write_b64 v11, v[244:245]
    v_add_u32 v11, 28, v9
    v_xor_b32 v11, v11, v5
    v_lshlrev_b32 v11, 4, v11
    v_add_u32 v11, v11, v10
    ds_write_b64 v11, v[246:247]
    v_lshlrev_b32 v9, 4, v1
    v_add_u32 v9, s26, v9
    s_lshl_b32 s30, s28, 18
    s_lshl_b32 s31, s27, 6
    s_add_u32 s30, s30, s31
    s_add_u32 s30, s30, 8257536
    s_waitcnt lgkmcnt(0)
    ds_read_b128 v[16:19], v9 offset:0
    ds_read_b128 v[20:23], v9 offset:1024
    ds_read_b128 v[24:27], v9 offset:2048
    ds_read_b128 v[28:31], v9 offset:3072
    v_lshrrev_b32 v10, 5, v1
    v_add_u32 v10, 0, v10
    v_add_u32 v11, 0, v1
    v_xor_b32 v11, v11, v10
    v_lshrrev_b32 v10, 2, v11
    v_and_b32 v11, 3, v11
    v_lshlrev_b32 v10, 12, v10
    v_lshlrev_b32 v11, 4, v11
    v_add_u32 v40, v10, v11
    v_lshrrev_b32 v10, 5, v1
    v_add_u32 v10, 2, v10
    v_add_u32 v11, 64, v1
    v_xor_b32 v11, v11, v10
    v_lshrrev_b32 v10, 2, v11
    v_and_b32 v11, 3, v11
    v_lshlrev_b32 v10, 12, v10
    v_lshlrev_b32 v11, 4, v11
    v_add_u32 v41, v10, v11
    v_lshrrev_b32 v10, 5, v1
    v_add_u32 v10, 4, v10
    v_add_u32 v11, 128, v1
    v_xor_b32 v11, v11, v10
    v_lshrrev_b32 v10, 2, v11
    v_and_b32 v11, 3, v11
    v_lshlrev_b32 v10, 12, v10
    v_lshlrev_b32 v11, 4, v11
    v_add_u32 v42, v10, v11
    v_lshrrev_b32 v10, 5, v1
    v_add_u32 v10, 6, v10
    v_add_u32 v11, 192, v1
    v_xor_b32 v11, v11, v10
    v_lshrrev_b32 v10, 2, v11
    v_and_b32 v11, 3, v11
    v_lshlrev_b32 v10, 12, v10
    v_lshlrev_b32 v11, 4, v11
    v_add_u32 v43, v10, v11
    s_waitcnt lgkmcnt(3)
    buffer_store_dwordx4 v[16:19], v40, s[16:19], s30 offen sc1
    s_waitcnt lgkmcnt(2)
    buffer_store_dwordx4 v[20:23], v41, s[16:19], s30 offen sc1
    s_waitcnt lgkmcnt(1)
    buffer_store_dwordx4 v[24:27], v42, s[16:19], s30 offen sc1
    s_waitcnt lgkmcnt(0)
    buffer_store_dwordx4 v[28:31], v43, s[16:19], s30 offen sc1
    s_mov_b32 s49, 13516800
A_post:
    v_mov_b32 v12, 0
    buffer_load_dword v13, v12, s[40:43], 0 offen sc1
    s_waitcnt vmcnt(0)
    v_mov_b32 v9, 115088
    v_mov_b32 v10, 1
    s_mov_b64 exec, 1
    ds_add_rtn_u32 v11, v9, v10
    s_waitcnt lgkmcnt(0)
    v_readfirstlane_b32 s38, v11
    s_cmp_lg_u32 s38, 3
    s_cbranch_scc1 A_noflag
    s_mov_b32 s39, 0
A_clr:
    v_readfirstlane_b32 s38, v13
    s_cmp_eq_u32 s38, 1
    s_cbranch_scc1 A_flag
    s_add_u32 s39, s39, 1
    s_cmp_ge_u32 s39, 0x40000
    s_cbranch_scc1 A_flag
    s_sleep 8
    buffer_load_dword v13, v12, s[40:43], 0 offen sc1
    s_waitcnt vmcnt(0)
    s_branch A_clr
A_flag:
    s_lshl_b32 s38, s2, 7
    s_add_u32 s38, s38, s49
    buffer_store_dword v10, v12, s[16:19], s38 offen sc1
A_noflag:
    s_mov_b64 exec, -1
    s_branch A_conv
A_w2prep:
    s_load_dwordx2 s[4:5], s[0:1], 72
    s_load_dwordx2 s[6:7], s[0:1], 96
    s_sub_u32 s25, s25, 640
    s_mul_i32 s27, s25, 1366
    s_lshr_b32 s27, s27, 16
    s_mul_i32 s28, s27, 48
    s_sub_u32 s28, s25, s28
    s_mul_i32 s29, s28, 40960
    s_mul_i32 s30, s27, 160
    s_add_u32 s29, s29, s30
    s_mov_b32 s38, 6554
    s_waitcnt lgkmcnt(0)
    s_mov_b32 s8, s4
    s_mov_b32 s9, s5
    s_mov_b32 s10, 1966080
    s_mov_b32 s11, 0x00020000
    s_mov_b32 s16, s34
    s_mov_b32 s17, s35
    s_mov_b32 s18, 13680640
    s_mov_b32 s19, 0x00020000
    s_mov_b32 s40, s6
    s_mov_b32 s41, s7
    s_mov_b32 s42, 256
    s_mov_b32 s43, 0x00020000
    v_add_u32 v4, 0, v1
    v_mul_lo_u32 v5, v4, s38
    v_lshrrev_b32 v5, 16, v5
    v_mul_u32_u24 v6, 10, v5
    v_sub_u32 v6, v4, v6
    v_mul_u32_u24 v5, 1280, v5
    v_lshlrev_b32 v6, 4, v6
    v_add_u32 v5, v5, v6
    s_add_u32 m0, s26, 0
    s_nop 0
    buffer_load_dwordx4 v5, s[8:11], s29 offen lds
    v_add_u32 v4, 64, v1
    v_mul_lo_u32 v5, v4, s38
    v_lshrrev_b32 v5, 16, v5
    v_mul_u32_u24 v6, 10, v5
    v_sub_u32 v6, v4, v6
    v_mul_u32_u24 v5, 1280, v5
    v_lshlrev_b32 v6, 4, v6
    v_add_u32 v5, v5, v6
    s_add_u32 m0, s26, 1024
    s_nop 0
    buffer_load_dwordx4 v5, s[8:11], s29 offen lds
    v_add_u32 v4, 128, v1
    v_mul_lo_u32 v5, v4, s38
    v_lshrrev_b32 v5, 16, v5
    v_mul_u32_u24 v6, 10, v5
    v_sub_u32 v6, v4, v6
    v_mul_u32_u24 v5, 1280, v5
    v_lshlrev_b32 v6, 4, v6
    v_add_u32 v5, v5, v6
    s_add_u32 m0, s26, 2048
    s_nop 0
    buffer_load_dwordx4 v5, s[8:11], s29 offen lds
    v_add_u32 v4, 192, v1
    v_mul_lo_u32 v5, v4, s38
    v_lshrrev_b32 v5, 16, v5
    v_mul_u32_u24 v6, 10, v5
    v_sub_u32 v6, v4, v6
    v_mul_u32_u24 v5, 1280, v5
    v_lshlrev_b32 v6, 4, v6
    v_add_u32 v5, v5, v6
    s_add_u32 m0, s26, 3072
    s_nop 0
    buffer_load_dwordx4 v5, s[8:11], s29 offen lds
    v_add_u32 v4, 256, v1
    v_mul_lo_u32 v5, v4, s38
    v_lshrrev_b32 v5, 16, v5
    v_mul_u32_u24 v6, 10, v5
    v_sub_u32 v6, v4, v6
    v_mul_u32_u24 v5, 1280, v5
    v_lshlrev_b32 v6, 4, v6
    v_add_u32 v5, v5, v6
    s_add_u32 m0, s26, 4096
    s_nop 0
    buffer_load_dwordx4 v5, s[8:11], s29 offen lds
    s_barrier
    v_bfe_u32 v4, v1, 2, 2
    v_lshlrev_b32 v5, 2, v3
    v_add_u32 v4, v4, v5
    v_mul_u32_u24 v4, 160, v4
    v_and_b32 v5, 3, v1
    v_lshlrev_b32 v5, 3, v5
    v_add_u32 v4, v4, v5
    v_add_u32 v4, s26, v4
    s_mul_i32 s30, s25, 5120
    s_add_u32 s30, s30, 6291456
    v_lshlrev_b32 v6, 4, v1
    v_add_u32 v7, 4096, v6
    s_waitcnt vmcnt(0)
    ds_read_b64_tr_b16 v[16:17], v4 offset:0
    ds_read_b64_tr_b16 v[18:19], v4 offset:2560
    ds_read_b64_tr_b16 v[20:21], v4 offset:32
    ds_read_b64_tr_b16 v[22:23], v4 offset:2592
    ds_read_b64_tr_b16 v[24:25], v4 offset:64
    ds_read_b64_tr_b16 v[26:27], v4 offset:2624
    ds_read_b64_tr_b16 v[28:29], v4 offset:96
    ds_read_b64_tr_b16 v[30:31], v4 offset:2656
    ds_read_b64_tr_b16 v[32:33], v4 offset:128
    ds_read_b64_tr_b16 v[34:35], v4 offset:2688
    s_waitcnt lgkmcnt(0)
    buffer_store_dwordx4 v[16:19], v6, s[16:19], s30 offen offset:0 sc1
    buffer_store_dwordx4 v[20:23], v6, s[16:19], s30 offen offset:1024 sc1
    buffer_store_dwordx4 v[24:27], v6, s[16:19], s30 offen offset:2048 sc1
    buffer_store_dwordx4 v[28:31], v6, s[16:19], s30 offen offset:3072 sc1
    buffer_store_dwordx4 v[32:35], v7, s[16:19], s30 offen offset:0 sc1
    s_mov_b32 s49, 13516812
    s_branch A_post
    s_waitcnt vmcnt(0)
A_conv:
    s_load_dwordx2 s[4:5], s[0:1], 32
    s_load_dwordx2 s[6:7], s[0:1], 40
    s_load_dwordx2 s[32:33], s[0:1], 96
    s_and_b32 s25, s2, 7
    s_lshr_b32 s26, s2, 3
    s_sub_u32 s27, s24, 4
    s_cmp_eq_u32 s27, 3
    s_cbranch_scc1 A_cend
    s_mul_i32 s28, s25, 80
    s_add_u32 s28, s28, s27
    s_cmp_ge_u32 s26, 16
    s_cbranch_scc1 A_two
    s_mul_i32 s29, s26, 3
    s_branch A_chan
A_two:
    s_cmp_eq_u32 s27, 2
    s_cbranch_scc1 A_cend
    s_lshl_b32 s29, s26, 1
    s_add_u32 s29, s29, 16
A_chan:
    s_add_u32 s28, s28, s29
    s_mul_i32 s30, s27, 12928
    s_add_u32 s30, s30, 115200
    s_lshl_b32 s36, s28, 12
    v_lshlrev_b32 v4, 4, v1
    s_waitcnt lgkmcnt(0)
    s_mov_b32 s8, s4
    s_mov_b32 s9, s5
    s_mov_b32 s10, 2621440
    s_mov_b32 s11, 0x00020000
    s_mov_b32 s12, s6
    s_mov_b32 s13, s7
    s_mov_b32 s14, 1280
    s_mov_b32 s15, 0x00020000
    s_mov_b32 s20, s32
    s_mov_b32 s21, s33
    s_mov_b32 s22, 256
    s_mov_b32 s23, 0x00020000
    s_mov_b32 s37, s36
    buffer_load_dwordx4 v[40:43], v4, s[8:11], s37 offen
    buffer_load_dword v44, v4, s[8:11], s37 offen offset:16
    s_add_u32 s37, s37, 1024
    buffer_load_dwordx4 v[46:49], v4, s[8:11], s37 offen
    buffer_load_dword v50, v4, s[8:11], s37 offen offset:16
    s_add_u32 s37, s37, 1024
    buffer_load_dwordx4 v[52:55], v4, s[8:11], s37 offen
    buffer_load_dword v56, v4, s[8:11], s37 offen offset:16
    s_add_u32 s37, s37, 1024
    buffer_load_dwordx4 v[58:61], v4, s[8:11], s37 offen
    buffer_load_dword v62, v4, s[8:11], s37 offen offset:16
    s_add_u32 s37, s37, 1024
    v_and_b32 v205, 1, v3
    v_add_u32 v200, v2, v205
    v_subrev_u32 v200, 16, v200
    v_lshlrev_b32 v201, 1, v200
    v_add_u32 v201, s36, v201
    v_cmp_gt_i32 vcc, 0, v200
    v_bfrev_b32 v202, 1
    s_nop 0
    v_cndmask_b32 v201, v201, v202, vcc
    buffer_load_ushort v204, v201, s[8:11], 0 offen
    s_lshl_b32 s38, s28, 1
    v_mov_b32 v201, s38
    buffer_load_ushort v206, v201, s[12:15], 0 offen
    v_mul_u32_u24 v202, 4160, v205
    v_lshlrev_b32 v203, 1, v2
    v_add_u32 v202, v202, v203
    v_add_u32 v202, s30, v202
    s_cmp_lg_u32 s27, 0
    s_cbranch_scc1 A_follow
    v_mov_b32 v210, 0
    s_mov_b32 s40, 0
A_seen:
    buffer_load_dword v212, v210, s[20:23], 0 offen sc1
    s_add_u32 s40, s40, 1
    s_waitcnt vmcnt(0)
    v_readfirstlane_b32 s38, v212
    s_cmp_eq_u32 s38, 1
    s_cbranch_scc1 A_seen_ok
    s_cmp_ge_u32 s40, 0x40000
    s_cbranch_scc1 A_seen_ok
    s_sleep 8
    s_branch A_seen
A_seen_ok:
    v_mov_b32 v233, 115072
A_stage:
    ds_read_b128 v[228:231], v233
    s_waitcnt lgkmcnt(0)
    v_min3_u32 v228, v228, v229, v230
    v_min_u32 v228, v228, v231
    v_cmp_gt_u32 vcc, 6, v228
    s_nop 1
    s_cbranch_vccz A_stage_ok
    s_sleep 2
    s_branch A_stage
A_stage_ok:
    s_cmp_ge_u32 s26, 16
    s_cselect_b32 s38, 1, 2
    s_add_u32 s38, s38, s28
    s_lshr_b32 s38, s38, 6
    s_lshl_b32 s38, s38, 4
    s_lshr_b32 s39, s28, 6
    s_lshl_b32 s39, s39, 4
    v_mov_b32 v210, s38
    v_mov_b32 v211, s39
    v_and_b32 v212, 16, v1
    v_cmp_eq_u32 vcc, 0, v212
    s_mov_b32 s40, 0
    v_cndmask_b32 v210, v210, v211, vcc
    v_add_u32 v210, v210, v2
    v_lshlrev_b32 v210, 7, v210
    v_add_u32 v210, 13516800, v210
A_poll:
    s_add_u32 s40, s40, 1
    s_cmp_ge_u32 s40, 0x40000
    s_cbranch_scc1 A_ready
    buffer_load_dword v212, v210, s[16:19], 0 offen sc1
    s_waitcnt vmcnt(0)
    v_cmp_ne_u32 vcc, 1, v212
    s_nop 1
    s_cbranch_vccz A_ready
    s_sleep 8
    s_branch A_poll
A_ready:
    v_mov_b32 v210, 115092
    v_mov_b32 v211, 1
    s_mov_b64 exec, 1
    ds_write_b32 v210, v211
    s_mov_b64 exec, -1
    s_branch A_go
A_follow:
    v_mov_b32 v233, 115092
A_fw:
    ds_read_b32 v228, v233
    s_waitcnt lgkmcnt(0)
    v_cmp_gt_u32 vcc, 1, v228
    s_nop 1
    s_cbranch_vccz A_fw_ok
    s_sleep 2
    s_branch A_fw
A_fw_ok:
A_go:
    s_add_u32 s37, s36, 8257536
    buffer_load_dwordx4 v[64:67], v4, s[16:19], s37 offen sc1
    s_add_u32 s37, s37, 1024
    buffer_load_dwordx4 v[68:71], v4, s[16:19], s37 offen sc1
    s_add_u32 s37, s37, 1024
    buffer_load_dwordx4 v[72:75], v4, s[16:19], s37 offen sc1
    s_add_u32 s37, s37, 1024
    buffer_load_dwordx4 v[76:79], v4, s[16:19], s37 offen sc1
    s_add_u32 s37, s37, 1024
    s_setprio 1
    v_add_u32 v207, s30, v4
    v_lshlrev_b32 v201, 3, v1
    v_add_u32 v201, s30, v201
    v_mov_b32 v208, 0
    v_mov_b32 v209, 0
    ds_write_b64 v201, v[208:209] offset:8320
    s_waitcnt vmcnt(4)
    ds_write_b16 v202, v204
    v_lshlrev_b32 v7, 16, v206
    ds_write_b128 v207, v[40:43] offset:32
    v_alignbyte_b32 v80, v41, v40, 2
    v_alignbyte_b32 v81, v42, v41, 2
    v_alignbyte_b32 v82, v43, v42, 2
    v_alignbyte_b32 v83, v44, v43, 2
    ds_write_b128 v207, v[80:83] offset:4192
    ds_write_b128 v207, v[46:49] offset:1056
    v_alignbyte_b32 v88, v47, v46, 2
    v_alignbyte_b32 v89, v48, v47, 2
    v_alignbyte_b32 v90, v49, v48, 2
    v_alignbyte_b32 v91, v50, v49, 2
    ds_write_b128 v207, v[88:91] offset:5216
    ds_write_b128 v207, v[52:55] offset:2080
    v_alignbyte_b32 v80, v53, v52, 2
    v_alignbyte_b32 v81, v54, v53, 2
    v_alignbyte_b32 v82, v55, v54, 2
    v_alignbyte_b32 v83, v56, v55, 2
    ds_write_b128 v207, v[80:83] offset:6240
    ds_write_b128 v207, v[58:61] offset:3104
    v_alignbyte_b32 v88, v59, v58, 2
    v_alignbyte_b32 v89, v60, v59, 2
    v_alignbyte_b32 v90, v61, v60, 2
    v_alignbyte_b32 v91, v62, v61, 2
    ds_write_b128 v207, v[88:91] offset:7264
    s_waitcnt vmcnt(0)
    ds_write_b128 v207, v[64:67] offset:8832
    ds_write_b128 v207, v[68:71] offset:9856
    ds_write_b128 v207, v[72:75] offset:10880
    ds_write_b128 v207, v[76:79] offset:11904
    v_lshlrev_b32 v201, 3, v3
    v_sub_u32 v201, v2, v201
    v_add_u32 v201, 9, v201
    v_and_b32 v203, 1, v201
    v_sub_u32 v201, v201, v203
    v_add_u32 v201, 16, v201
    v_lshlrev_b32 v201, 1, v201
    v_mul_u32_u24 v203, 4160, v203
    v_add_u32 v201, v201, v203
    v_add_u32 v212, s30, v201
    v_add_u32 v213, 1024, v212
    v_add_u32 v214, 2048, v212
    v_add_u32 v215, 3072, v212
    v_lshlrev_b32 v201, 5, v2
    v_lshlrev_b32 v203, 4, v3
    v_add_u32 v201, v201, v203
    v_add_u32 v201, s30, v201
    v_add_u32 v6, 8352, v201
    v_mov_b32 v8, 0
    v_mov_b32 v9, 0
    v_mov_b32 v10, 0
    v_mov_b32 v11, 0
    v_mov_b32 v12, 0
    v_mov_b32 v13, 0
    v_mov_b32 v14, 0
    v_mov_b32 v15, 0
    v_mov_b32 v16, 0
    v_mov_b32 v17, 0
    v_mov_b32 v18, 0
    v_mov_b32 v19, 0
    v_mov_b32 v20, 0
    v_mov_b32 v21, 0
    v_mov_b32 v22, 0
    v_mov_b32 v23, 0
    v_mov_b32 v24, 0
    v_mov_b32 v25, 0
    v_mov_b32 v26, 0
    v_mov_b32 v27, 0
    v_mov_b32 v28, 0
    v_mov_b32 v29, 0
    v_mov_b32 v30, 0
    v_mov_b32 v31, 0
    v_mov_b32 v32, 0
    v_mov_b32 v33, 0
    v_mov_b32 v34, 0
    v_mov_b32 v35, 0
    v_mov_b32 v36, 0
    v_mov_b32 v37, 0
    v_mov_b32 v38, 0
    v_mov_b32 v39, 0
    s_waitcnt lgkmcnt(0)
    ds_read_b128 v[72:75], v6 offset:448
    ds_read2_b32 v[40:41], v212 offset0:0 offset1:1
    ds_read2_b32 v[42:43], v212 offset0:2 offset1:3
    ds_read_b128 v[76:79], v6 offset:960
    ds_read2_b32 v[44:45], v212 offset0:128 offset1:129
    ds_read2_b32 v[46:47], v212 offset0:130 offset1:131
    ds_read_b128 v[80:83], v6 offset:1472
    ds_read2_b32 v[48:49], v213 offset0:0 offset1:1
    ds_read2_b32 v[50:51], v213 offset0:2 offset1:3
    ds_read_b128 v[84:87], v6 offset:1984
    ds_read2_b32 v[52:53], v213 offset0:128 offset1:129
    ds_read2_b32 v[54:55], v213 offset0:130 offset1:131
    ds_read_b128 v[88:91], v6 offset:2496
    ds_read2_b32 v[56:57], v214 offset0:0 offset1:1
    ds_read2_b32 v[58:59], v214 offset0:2 offset1:3
    ds_read_b128 v[92:95], v6 offset:3008
    ds_read2_b32 v[60:61], v214 offset0:128 offset1:129
    ds_read2_b32 v[62:63], v214 offset0:130 offset1:131
    ds_read_b128 v[96:99], v6 offset:3520
    ds_read2_b32 v[64:65], v215 offset0:0 offset1:1
    ds_read2_b32 v[66:67], v215 offset0:2 offset1:3
    ds_read_b128 v[100:103], v6 offset:4032
    ds_read2_b32 v[68:69], v215 offset0:128 offset1:129
    ds_read2_b32 v[70:71], v215 offset0:130 offset1:131
    s_waitcnt lgkmcnt(0)
    v_mfma_f32_16x16x32_bf16 v[8:11], v[40:43], v[72:75], v[8:11]
    ds_read_b128 v[136:139], v6 offset:384
    v_mfma_f32_16x16x32_bf16 v[12:15], v[40:43], v[76:79], v[12:15]
    ds_read2_b32 v[104:105], v212 offset0:16 offset1:17
    v_mfma_f32_16x16x32_bf16 v[16:19], v[40:43], v[80:83], v[16:19]
    ds_read2_b32 v[106:107], v212 offset0:18 offset1:19
    v_mfma_f32_16x16x32_bf16 v[20:23], v[40:43], v[84:87], v[20:23]
    ds_read_b128 v[140:143], v6 offset:896
    v_mfma_f32_16x16x32_bf16 v[24:27], v[40:43], v[88:91], v[24:27]
    ds_read2_b32 v[108:109], v212 offset0:144 offset1:145
    v_mfma_f32_16x16x32_bf16 v[28:31], v[40:43], v[92:95], v[28:31]
    ds_read2_b32 v[110:111], v212 offset0:146 offset1:147
    v_mfma_f32_16x16x32_bf16 v[32:35], v[40:43], v[96:99], v[32:35]
    ds_read_b128 v[144:147], v6 offset:1408
    v_mfma_f32_16x16x32_bf16 v[36:39], v[40:43], v[100:103], v[36:39]
    ds_read2_b32 v[112:113], v213 offset0:16 offset1:17
    v_mfma_f32_16x16x32_bf16 v[12:15], v[44:47], v[72:75], v[12:15]
    ds_read2_b32 v[114:115], v213 offset0:18 offset1:19
    v_mfma_f32_16x16x32_bf16 v[16:19], v[44:47], v[76:79], v[16:19]
    ds_read_b128 v[148:151], v6 offset:1920
    v_mfma_f32_16x16x32_bf16 v[20:23], v[44:47], v[80:83], v[20:23]
    ds_read2_b32 v[116:117], v213 offset0:144 offset1:145
    v_mfma_f32_16x16x32_bf16 v[24:27], v[44:47], v[84:87], v[24:27]
    ds_read2_b32 v[118:119], v213 offset0:146 offset1:147
    v_mfma_f32_16x16x32_bf16 v[28:31], v[44:47], v[88:91], v[28:31]
    ds_read_b128 v[152:155], v6 offset:2432
    v_mfma_f32_16x16x32_bf16 v[32:35], v[44:47], v[92:95], v[32:35]
    ds_read2_b32 v[120:121], v214 offset0:16 offset1:17
    v_mfma_f32_16x16x32_bf16 v[36:39], v[44:47], v[96:99], v[36:39]
    ds_read2_b32 v[122:123], v214 offset0:18 offset1:19
    v_mfma_f32_16x16x32_bf16 v[16:19], v[48:51], v[72:75], v[16:19]
    ds_read_b128 v[156:159], v6 offset:2944
    v_mfma_f32_16x16x32_bf16 v[20:23], v[48:51], v[76:79], v[20:23]
    ds_read2_b32 v[124:125], v214 offset0:144 offset1:145
    v_mfma_f32_16x16x32_bf16 v[24:27], v[48:51], v[80:83], v[24:27]
    ds_read2_b32 v[126:127], v214 offset0:146 offset1:147
    v_mfma_f32_16x16x32_bf16 v[28:31], v[48:51], v[84:87], v[28:31]
    ds_read_b128 v[160:163], v6 offset:3456
    v_mfma_f32_16x16x32_bf16 v[32:35], v[48:51], v[88:91], v[32:35]
    ds_read2_b32 v[128:129], v215 offset0:16 offset1:17
    v_mfma_f32_16x16x32_bf16 v[36:39], v[48:51], v[92:95], v[36:39]
    ds_read2_b32 v[130:131], v215 offset0:18 offset1:19
    v_mfma_f32_16x16x32_bf16 v[20:23], v[52:55], v[72:75], v[20:23]
    ds_read_b128 v[164:167], v6 offset:3968
    v_mfma_f32_16x16x32_bf16 v[24:27], v[52:55], v[76:79], v[24:27]
    ds_read2_b32 v[132:133], v215 offset0:144 offset1:145
    v_mfma_f32_16x16x32_bf16 v[28:31], v[52:55], v[80:83], v[28:31]
    ds_read2_b32 v[134:135], v215 offset0:146 offset1:147
    v_mfma_f32_16x16x32_bf16 v[32:35], v[52:55], v[84:87], v[32:35]
    v_mfma_f32_16x16x32_bf16 v[36:39], v[52:55], v[88:91], v[36:39]
    v_mfma_f32_16x16x32_bf16 v[24:27], v[56:59], v[72:75], v[24:27]
    v_mfma_f32_16x16x32_bf16 v[28:31], v[56:59], v[76:79], v[28:31]
    v_mfma_f32_16x16x32_bf16 v[32:35], v[56:59], v[80:83], v[32:35]
    v_mfma_f32_16x16x32_bf16 v[36:39], v[56:59], v[84:87], v[36:39]
    v_mfma_f32_16x16x32_bf16 v[28:31], v[60:63], v[72:75], v[28:31]
    v_mfma_f32_16x16x32_bf16 v[32:35], v[60:63], v[76:79], v[32:35]
    v_mfma_f32_16x16x32_bf16 v[36:39], v[60:63], v[80:83], v[36:39]
    v_mfma_f32_16x16x32_bf16 v[32:35], v[64:67], v[72:75], v[32:35]
    v_mfma_f32_16x16x32_bf16 v[36:39], v[64:67], v[76:79], v[36:39]
    v_mfma_f32_16x16x32_bf16 v[36:39], v[68:71], v[72:75], v[36:39]
    s_waitcnt lgkmcnt(0)
    v_mfma_f32_16x16x32_bf16 v[8:11], v[104:107], v[136:139], v[8:11]
    ds_read_b128 v[72:75], v6 offset:320
    v_mfma_f32_16x16x32_bf16 v[12:15], v[104:107], v[140:143], v[12:15]
    ds_read2_b32 v[40:41], v212 offset0:32 offset1:33
    v_mfma_f32_16x16x32_bf16 v[16:19], v[104:107], v[144:147], v[16:19]
    ds_read2_b32 v[42:43], v212 offset0:34 offset1:35
    v_mfma_f32_16x16x32_bf16 v[20:23], v[104:107], v[148:151], v[20:23]
    ds_read_b128 v[76:79], v6 offset:832
    v_mfma_f32_16x16x32_bf16 v[24:27], v[104:107], v[152:155], v[24:27]
    ds_read2_b32 v[44:45], v212 offset0:160 offset1:161
    v_mfma_f32_16x16x32_bf16 v[28:31], v[104:107], v[156:159], v[28:31]
    ds_read2_b32 v[46:47], v212 offset0:162 offset1:163
    v_mfma_f32_16x16x32_bf16 v[32:35], v[104:107], v[160:163], v[32:35]
    ds_read_b128 v[80:83], v6 offset:1344
    v_mfma_f32_16x16x32_bf16 v[36:39], v[104:107], v[164:167], v[36:39]
    ds_read2_b32 v[48:49], v213 offset0:32 offset1:33
    v_mfma_f32_16x16x32_bf16 v[12:15], v[108:111], v[136:139], v[12:15]
    ds_read2_b32 v[50:51], v213 offset0:34 offset1:35
    v_mfma_f32_16x16x32_bf16 v[16:19], v[108:111], v[140:143], v[16:19]
    ds_read_b128 v[84:87], v6 offset:1856
    v_mfma_f32_16x16x32_bf16 v[20:23], v[108:111], v[144:147], v[20:23]
    ds_read2_b32 v[52:53], v213 offset0:160 offset1:161
    v_mfma_f32_16x16x32_bf16 v[24:27], v[108:111], v[148:151], v[24:27]
    ds_read2_b32 v[54:55], v213 offset0:162 offset1:163
    v_mfma_f32_16x16x32_bf16 v[28:31], v[108:111], v[152:155], v[28:31]
    ds_read_b128 v[88:91], v6 offset:2368
    v_mfma_f32_16x16x32_bf16 v[32:35], v[108:111], v[156:159], v[32:35]
    ds_read2_b32 v[56:57], v214 offset0:32 offset1:33
    v_mfma_f32_16x16x32_bf16 v[36:39], v[108:111], v[160:163], v[36:39]
    ds_read2_b32 v[58:59], v214 offset0:34 offset1:35
    v_mfma_f32_16x16x32_bf16 v[16:19], v[112:115], v[136:139], v[16:19]
    ds_read_b128 v[92:95], v6 offset:2880
    v_mfma_f32_16x16x32_bf16 v[20:23], v[112:115], v[140:143], v[20:23]
    ds_read2_b32 v[60:61], v214 offset0:160 offset1:161
    v_mfma_f32_16x16x32_bf16 v[24:27], v[112:115], v[144:147], v[24:27]
    ds_read2_b32 v[62:63], v214 offset0:162 offset1:163
    v_mfma_f32_16x16x32_bf16 v[28:31], v[112:115], v[148:151], v[28:31]
    ds_read_b128 v[96:99], v6 offset:3392
    v_mfma_f32_16x16x32_bf16 v[32:35], v[112:115], v[152:155], v[32:35]
    ds_read2_b32 v[64:65], v215 offset0:32 offset1:33
    v_mfma_f32_16x16x32_bf16 v[36:39], v[112:115], v[156:159], v[36:39]
    ds_read2_b32 v[66:67], v215 offset0:34 offset1:35
    v_mfma_f32_16x16x32_bf16 v[20:23], v[116:119], v[136:139], v[20:23]
    ds_read_b128 v[100:103], v6 offset:3904
    v_mfma_f32_16x16x32_bf16 v[24:27], v[116:119], v[140:143], v[24:27]
    ds_read2_b32 v[68:69], v215 offset0:160 offset1:161
    v_mfma_f32_16x16x32_bf16 v[28:31], v[116:119], v[144:147], v[28:31]
    ds_read2_b32 v[70:71], v215 offset0:162 offset1:163
    v_mfma_f32_16x16x32_bf16 v[32:35], v[116:119], v[148:151], v[32:35]
    v_mfma_f32_16x16x32_bf16 v[36:39], v[116:119], v[152:155], v[36:39]
    v_mfma_f32_16x16x32_bf16 v[24:27], v[120:123], v[136:139], v[24:27]
    v_mfma_f32_16x16x32_bf16 v[28:31], v[120:123], v[140:143], v[28:31]
    v_mfma_f32_16x16x32_bf16 v[32:35], v[120:123], v[144:147], v[32:35]
    v_mfma_f32_16x16x32_bf16 v[36:39], v[120:123], v[148:151], v[36:39]
    v_mfma_f32_16x16x32_bf16 v[28:31], v[124:127], v[136:139], v[28:31]
    v_mfma_f32_16x16x32_bf16 v[32:35], v[124:127], v[140:143], v[32:35]
    v_mfma_f32_16x16x32_bf16 v[36:39], v[124:127], v[144:147], v[36:39]
    v_mfma_f32_16x16x32_bf16 v[32:35], v[128:131], v[136:139], v[32:35]
    v_mfma_f32_16x16x32_bf16 v[36:39], v[128:131], v[140:143], v[36:39]
    v_mfma_f32_16x16x32_bf16 v[36:39], v[132:135], v[136:139], v[36:39]
    s_waitcnt lgkmcnt(0)
    v_mfma_f32_16x16x32_bf16 v[8:11], v[40:43], v[72:75], v[8:11]
    ds_read_b128 v[136:139], v6 offset:256
    v_mfma_f32_16x16x32_bf16 v[12:15], v[40:43], v[76:79], v[12:15]
    ds_read2_b32 v[104:105], v212 offset0:48 offset1:49
    v_mfma_f32_16x16x32_bf16 v[16:19], v[40:43], v[80:83], v[16:19]
    ds_read2_b32 v[106:107], v212 offset0:50 offset1:51
    v_mfma_f32_16x16x32_bf16 v[20:23], v[40:43], v[84:87], v[20:23]
    ds_read_b128 v[140:143], v6 offset:768
    v_mfma_f32_16x16x32_bf16 v[24:27], v[40:43], v[88:91], v[24:27]
    ds_read2_b32 v[108:109], v212 offset0:176 offset1:177
    v_mfma_f32_16x16x32_bf16 v[28:31], v[40:43], v[92:95], v[28:31]
    ds_read2_b32 v[110:111], v212 offset0:178 offset1:179
    v_mfma_f32_16x16x32_bf16 v[32:35], v[40:43], v[96:99], v[32:35]
    ds_read_b128 v[144:147], v6 offset:1280
    v_mfma_f32_16x16x32_bf16 v[36:39], v[40:43], v[100:103], v[36:39]
    ds_read2_b32 v[112:113], v213 offset0:48 offset1:49
    v_mfma_f32_16x16x32_bf16 v[12:15], v[44:47], v[72:75], v[12:15]
    ds_read2_b32 v[114:115], v213 offset0:50 offset1:51
    v_mfma_f32_16x16x32_bf16 v[16:19], v[44:47], v[76:79], v[16:19]
    ds_read_b128 v[148:151], v6 offset:1792
    v_mfma_f32_16x16x32_bf16 v[20:23], v[44:47], v[80:83], v[20:23]
    ds_read2_b32 v[116:117], v213 offset0:176 offset1:177
    v_mfma_f32_16x16x32_bf16 v[24:27], v[44:47], v[84:87], v[24:27]
    ds_read2_b32 v[118:119], v213 offset0:178 offset1:179
    v_mfma_f32_16x16x32_bf16 v[28:31], v[44:47], v[88:91], v[28:31]
    ds_read_b128 v[152:155], v6 offset:2304
    v_mfma_f32_16x16x32_bf16 v[32:35], v[44:47], v[92:95], v[32:35]
    ds_read2_b32 v[120:121], v214 offset0:48 offset1:49
    v_mfma_f32_16x16x32_bf16 v[36:39], v[44:47], v[96:99], v[36:39]
    ds_read2_b32 v[122:123], v214 offset0:50 offset1:51
    v_mfma_f32_16x16x32_bf16 v[16:19], v[48:51], v[72:75], v[16:19]
    ds_read_b128 v[156:159], v6 offset:2816
    v_mfma_f32_16x16x32_bf16 v[20:23], v[48:51], v[76:79], v[20:23]
    ds_read2_b32 v[124:125], v214 offset0:176 offset1:177
    v_mfma_f32_16x16x32_bf16 v[24:27], v[48:51], v[80:83], v[24:27]
    ds_read2_b32 v[126:127], v214 offset0:178 offset1:179
    v_mfma_f32_16x16x32_bf16 v[28:31], v[48:51], v[84:87], v[28:31]
    ds_read_b128 v[160:163], v6 offset:3328
    v_mfma_f32_16x16x32_bf16 v[32:35], v[48:51], v[88:91], v[32:35]
    ds_read2_b32 v[128:129], v215 offset0:48 offset1:49
    v_mfma_f32_16x16x32_bf16 v[36:39], v[48:51], v[92:95], v[36:39]
    ds_read2_b32 v[130:131], v215 offset0:50 offset1:51
    v_mfma_f32_16x16x32_bf16 v[20:23], v[52:55], v[72:75], v[20:23]
    ds_read_b128 v[164:167], v6 offset:3840
    v_mfma_f32_16x16x32_bf16 v[24:27], v[52:55], v[76:79], v[24:27]
    ds_read2_b32 v[132:133], v215 offset0:176 offset1:177
    v_mfma_f32_16x16x32_bf16 v[28:31], v[52:55], v[80:83], v[28:31]
    ds_read2_b32 v[134:135], v215 offset0:178 offset1:179
    v_mfma_f32_16x16x32_bf16 v[32:35], v[52:55], v[84:87], v[32:35]
    v_mfma_f32_16x16x32_bf16 v[36:39], v[52:55], v[88:91], v[36:39]
    v_mfma_f32_16x16x32_bf16 v[24:27], v[56:59], v[72:75], v[24:27]
    v_mfma_f32_16x16x32_bf16 v[28:31], v[56:59], v[76:79], v[28:31]
    v_mfma_f32_16x16x32_bf16 v[32:35], v[56:59], v[80:83], v[32:35]
    v_mfma_f32_16x16x32_bf16 v[36:39], v[56:59], v[84:87], v[36:39]
    v_mfma_f32_16x16x32_bf16 v[28:31], v[60:63], v[72:75], v[28:31]
    v_mfma_f32_16x16x32_bf16 v[32:35], v[60:63], v[76:79], v[32:35]
    v_mfma_f32_16x16x32_bf16 v[36:39], v[60:63], v[80:83], v[36:39]
    v_mfma_f32_16x16x32_bf16 v[32:35], v[64:67], v[72:75], v[32:35]
    v_mfma_f32_16x16x32_bf16 v[36:39], v[64:67], v[76:79], v[36:39]
    v_mfma_f32_16x16x32_bf16 v[36:39], v[68:71], v[72:75], v[36:39]
    s_waitcnt lgkmcnt(0)
    v_mfma_f32_16x16x32_bf16 v[8:11], v[104:107], v[136:139], v[8:11]
    ds_read_b128 v[72:75], v6 offset:192
    v_mfma_f32_16x16x32_bf16 v[12:15], v[104:107], v[140:143], v[12:15]
    ds_read2_b32 v[40:41], v212 offset0:64 offset1:65
    v_mfma_f32_16x16x32_bf16 v[16:19], v[104:107], v[144:147], v[16:19]
    ds_read2_b32 v[42:43], v212 offset0:66 offset1:67
    v_mfma_f32_16x16x32_bf16 v[20:23], v[104:107], v[148:151], v[20:23]
    ds_read_b128 v[76:79], v6 offset:704
    v_mfma_f32_16x16x32_bf16 v[24:27], v[104:107], v[152:155], v[24:27]
    ds_read2_b32 v[44:45], v212 offset0:192 offset1:193
    v_mfma_f32_16x16x32_bf16 v[28:31], v[104:107], v[156:159], v[28:31]
    ds_read2_b32 v[46:47], v212 offset0:194 offset1:195
    v_mfma_f32_16x16x32_bf16 v[32:35], v[104:107], v[160:163], v[32:35]
    ds_read_b128 v[80:83], v6 offset:1216
    v_mfma_f32_16x16x32_bf16 v[36:39], v[104:107], v[164:167], v[36:39]
    ds_read2_b32 v[48:49], v213 offset0:64 offset1:65
    v_mfma_f32_16x16x32_bf16 v[12:15], v[108:111], v[136:139], v[12:15]
    ds_read2_b32 v[50:51], v213 offset0:66 offset1:67
    v_mfma_f32_16x16x32_bf16 v[16:19], v[108:111], v[140:143], v[16:19]
    ds_read_b128 v[84:87], v6 offset:1728
    v_mfma_f32_16x16x32_bf16 v[20:23], v[108:111], v[144:147], v[20:23]
    ds_read2_b32 v[52:53], v213 offset0:192 offset1:193
    v_mfma_f32_16x16x32_bf16 v[24:27], v[108:111], v[148:151], v[24:27]
    ds_read2_b32 v[54:55], v213 offset0:194 offset1:195
    v_mfma_f32_16x16x32_bf16 v[28:31], v[108:111], v[152:155], v[28:31]
    ds_read_b128 v[88:91], v6 offset:2240
    v_mfma_f32_16x16x32_bf16 v[32:35], v[108:111], v[156:159], v[32:35]
    ds_read2_b32 v[56:57], v214 offset0:64 offset1:65
    v_mfma_f32_16x16x32_bf16 v[36:39], v[108:111], v[160:163], v[36:39]
    ds_read2_b32 v[58:59], v214 offset0:66 offset1:67
    v_mfma_f32_16x16x32_bf16 v[16:19], v[112:115], v[136:139], v[16:19]
    ds_read_b128 v[92:95], v6 offset:2752
    v_mfma_f32_16x16x32_bf16 v[20:23], v[112:115], v[140:143], v[20:23]
    ds_read2_b32 v[60:61], v214 offset0:192 offset1:193
    v_mfma_f32_16x16x32_bf16 v[24:27], v[112:115], v[144:147], v[24:27]
    ds_read2_b32 v[62:63], v214 offset0:194 offset1:195
    v_mfma_f32_16x16x32_bf16 v[28:31], v[112:115], v[148:151], v[28:31]
    ds_read_b128 v[96:99], v6 offset:3264
    v_mfma_f32_16x16x32_bf16 v[32:35], v[112:115], v[152:155], v[32:35]
    ds_read2_b32 v[64:65], v215 offset0:64 offset1:65
    v_mfma_f32_16x16x32_bf16 v[36:39], v[112:115], v[156:159], v[36:39]
    ds_read2_b32 v[66:67], v215 offset0:66 offset1:67
    v_mfma_f32_16x16x32_bf16 v[20:23], v[116:119], v[136:139], v[20:23]
    ds_read_b128 v[100:103], v6 offset:3776
    v_mfma_f32_16x16x32_bf16 v[24:27], v[116:119], v[140:143], v[24:27]
    ds_read2_b32 v[68:69], v215 offset0:192 offset1:193
    v_mfma_f32_16x16x32_bf16 v[28:31], v[116:119], v[144:147], v[28:31]
    ds_read2_b32 v[70:71], v215 offset0:194 offset1:195
    v_mfma_f32_16x16x32_bf16 v[32:35], v[116:119], v[148:151], v[32:35]
    v_mfma_f32_16x16x32_bf16 v[36:39], v[116:119], v[152:155], v[36:39]
    v_mfma_f32_16x16x32_bf16 v[24:27], v[120:123], v[136:139], v[24:27]
    v_mfma_f32_16x16x32_bf16 v[28:31], v[120:123], v[140:143], v[28:31]
    v_mfma_f32_16x16x32_bf16 v[32:35], v[120:123], v[144:147], v[32:35]
    v_mfma_f32_16x16x32_bf16 v[36:39], v[120:123], v[148:151], v[36:39]
    v_mfma_f32_16x16x32_bf16 v[28:31], v[124:127], v[136:139], v[28:31]
    v_mfma_f32_16x16x32_bf16 v[32:35], v[124:127], v[140:143], v[32:35]
    v_mfma_f32_16x16x32_bf16 v[36:39], v[124:127], v[144:147], v[36:39]
    v_mfma_f32_16x16x32_bf16 v[32:35], v[128:131], v[136:139], v[32:35]
    v_mfma_f32_16x16x32_bf16 v[36:39], v[128:131], v[140:143], v[36:39]
    v_mfma_f32_16x16x32_bf16 v[36:39], v[132:135], v[136:139], v[36:39]
    s_waitcnt lgkmcnt(0)
    v_mfma_f32_16x16x32_bf16 v[8:11], v[40:43], v[72:75], v[8:11]
    ds_read_b128 v[136:139], v6 offset:128
    v_mfma_f32_16x16x32_bf16 v[12:15], v[40:43], v[76:79], v[12:15]
    ds_read2_b32 v[104:105], v212 offset0:80 offset1:81
    v_mfma_f32_16x16x32_bf16 v[16:19], v[40:43], v[80:83], v[16:19]
    ds_read2_b32 v[106:107], v212 offset0:82 offset1:83
    v_mfma_f32_16x16x32_bf16 v[20:23], v[40:43], v[84:87], v[20:23]
    ds_read_b128 v[140:143], v6 offset:640
    v_mfma_f32_16x16x32_bf16 v[24:27], v[40:43], v[88:91], v[24:27]
    ds_read2_b32 v[108:109], v212 offset0:208 offset1:209
    v_mfma_f32_16x16x32_bf16 v[28:31], v[40:43], v[92:95], v[28:31]
    ds_read2_b32 v[110:111], v212 offset0:210 offset1:211
    v_mfma_f32_16x16x32_bf16 v[32:35], v[40:43], v[96:99], v[32:35]
    ds_read_b128 v[144:147], v6 offset:1152
    v_mfma_f32_16x16x32_bf16 v[36:39], v[40:43], v[100:103], v[36:39]
    ds_read2_b32 v[112:113], v213 offset0:80 offset1:81
    v_mfma_f32_16x16x32_bf16 v[12:15], v[44:47], v[72:75], v[12:15]
    ds_read2_b32 v[114:115], v213 offset0:82 offset1:83
    v_mfma_f32_16x16x32_bf16 v[16:19], v[44:47], v[76:79], v[16:19]
    ds_read_b128 v[148:151], v6 offset:1664
    v_mfma_f32_16x16x32_bf16 v[20:23], v[44:47], v[80:83], v[20:23]
    ds_read2_b32 v[116:117], v213 offset0:208 offset1:209
    v_mfma_f32_16x16x32_bf16 v[24:27], v[44:47], v[84:87], v[24:27]
    ds_read2_b32 v[118:119], v213 offset0:210 offset1:211
    v_mfma_f32_16x16x32_bf16 v[28:31], v[44:47], v[88:91], v[28:31]
    ds_read_b128 v[152:155], v6 offset:2176
    v_mfma_f32_16x16x32_bf16 v[32:35], v[44:47], v[92:95], v[32:35]
    ds_read2_b32 v[120:121], v214 offset0:80 offset1:81
    v_mfma_f32_16x16x32_bf16 v[36:39], v[44:47], v[96:99], v[36:39]
    ds_read2_b32 v[122:123], v214 offset0:82 offset1:83
    v_mfma_f32_16x16x32_bf16 v[16:19], v[48:51], v[72:75], v[16:19]
    ds_read_b128 v[156:159], v6 offset:2688
    v_mfma_f32_16x16x32_bf16 v[20:23], v[48:51], v[76:79], v[20:23]
    ds_read2_b32 v[124:125], v214 offset0:208 offset1:209
    v_mfma_f32_16x16x32_bf16 v[24:27], v[48:51], v[80:83], v[24:27]
    ds_read2_b32 v[126:127], v214 offset0:210 offset1:211
    v_mfma_f32_16x16x32_bf16 v[28:31], v[48:51], v[84:87], v[28:31]
    ds_read_b128 v[160:163], v6 offset:3200
    v_mfma_f32_16x16x32_bf16 v[32:35], v[48:51], v[88:91], v[32:35]
    ds_read2_b32 v[128:129], v215 offset0:80 offset1:81
    v_mfma_f32_16x16x32_bf16 v[36:39], v[48:51], v[92:95], v[36:39]
    ds_read2_b32 v[130:131], v215 offset0:82 offset1:83
    v_mfma_f32_16x16x32_bf16 v[20:23], v[52:55], v[72:75], v[20:23]
    ds_read_b128 v[164:167], v6 offset:3712
    v_mfma_f32_16x16x32_bf16 v[24:27], v[52:55], v[76:79], v[24:27]
    ds_read2_b32 v[132:133], v215 offset0:208 offset1:209
    v_mfma_f32_16x16x32_bf16 v[28:31], v[52:55], v[80:83], v[28:31]
    ds_read2_b32 v[134:135], v215 offset0:210 offset1:211
    v_mfma_f32_16x16x32_bf16 v[32:35], v[52:55], v[84:87], v[32:35]
    v_mfma_f32_16x16x32_bf16 v[36:39], v[52:55], v[88:91], v[36:39]
    v_mfma_f32_16x16x32_bf16 v[24:27], v[56:59], v[72:75], v[24:27]
    v_mfma_f32_16x16x32_bf16 v[28:31], v[56:59], v[76:79], v[28:31]
    v_mfma_f32_16x16x32_bf16 v[32:35], v[56:59], v[80:83], v[32:35]
    v_mfma_f32_16x16x32_bf16 v[36:39], v[56:59], v[84:87], v[36:39]
    v_mfma_f32_16x16x32_bf16 v[28:31], v[60:63], v[72:75], v[28:31]
    v_mfma_f32_16x16x32_bf16 v[32:35], v[60:63], v[76:79], v[32:35]
    v_mfma_f32_16x16x32_bf16 v[36:39], v[60:63], v[80:83], v[36:39]
    v_mfma_f32_16x16x32_bf16 v[32:35], v[64:67], v[72:75], v[32:35]
    v_mfma_f32_16x16x32_bf16 v[36:39], v[64:67], v[76:79], v[36:39]
    v_mfma_f32_16x16x32_bf16 v[36:39], v[68:71], v[72:75], v[36:39]
    s_waitcnt lgkmcnt(0)
    v_mfma_f32_16x16x32_bf16 v[8:11], v[104:107], v[136:139], v[8:11]
    ds_read_b128 v[72:75], v6 offset:64
    v_mfma_f32_16x16x32_bf16 v[12:15], v[104:107], v[140:143], v[12:15]
    ds_read2_b32 v[40:41], v212 offset0:96 offset1:97
    v_mfma_f32_16x16x32_bf16 v[16:19], v[104:107], v[144:147], v[16:19]
    ds_read2_b32 v[42:43], v212 offset0:98 offset1:99
    v_mfma_f32_16x16x32_bf16 v[20:23], v[104:107], v[148:151], v[20:23]
    ds_read_b128 v[76:79], v6 offset:576
    v_mfma_f32_16x16x32_bf16 v[24:27], v[104:107], v[152:155], v[24:27]
    ds_read2_b32 v[44:45], v212 offset0:224 offset1:225
    v_mfma_f32_16x16x32_bf16 v[28:31], v[104:107], v[156:159], v[28:31]
    ds_read2_b32 v[46:47], v212 offset0:226 offset1:227
    v_mfma_f32_16x16x32_bf16 v[32:35], v[104:107], v[160:163], v[32:35]
    ds_read_b128 v[80:83], v6 offset:1088
    v_mfma_f32_16x16x32_bf16 v[36:39], v[104:107], v[164:167], v[36:39]
    ds_read2_b32 v[48:49], v213 offset0:96 offset1:97
    v_mfma_f32_16x16x32_bf16 v[12:15], v[108:111], v[136:139], v[12:15]
    ds_read2_b32 v[50:51], v213 offset0:98 offset1:99
    v_mfma_f32_16x16x32_bf16 v[16:19], v[108:111], v[140:143], v[16:19]
    ds_read_b128 v[84:87], v6 offset:1600
    v_mfma_f32_16x16x32_bf16 v[20:23], v[108:111], v[144:147], v[20:23]
    ds_read2_b32 v[52:53], v213 offset0:224 offset1:225
    v_mfma_f32_16x16x32_bf16 v[24:27], v[108:111], v[148:151], v[24:27]
    ds_read2_b32 v[54:55], v213 offset0:226 offset1:227
    v_mfma_f32_16x16x32_bf16 v[28:31], v[108:111], v[152:155], v[28:31]
    ds_read_b128 v[88:91], v6 offset:2112
    v_mfma_f32_16x16x32_bf16 v[32:35], v[108:111], v[156:159], v[32:35]
    ds_read2_b32 v[56:57], v214 offset0:96 offset1:97
    v_mfma_f32_16x16x32_bf16 v[36:39], v[108:111], v[160:163], v[36:39]
    ds_read2_b32 v[58:59], v214 offset0:98 offset1:99
    v_mfma_f32_16x16x32_bf16 v[16:19], v[112:115], v[136:139], v[16:19]
    ds_read_b128 v[92:95], v6 offset:2624
    v_mfma_f32_16x16x32_bf16 v[20:23], v[112:115], v[140:143], v[20:23]
    ds_read2_b32 v[60:61], v214 offset0:224 offset1:225
    v_mfma_f32_16x16x32_bf16 v[24:27], v[112:115], v[144:147], v[24:27]
    ds_read2_b32 v[62:63], v214 offset0:226 offset1:227
    v_mfma_f32_16x16x32_bf16 v[28:31], v[112:115], v[148:151], v[28:31]
    ds_read_b128 v[96:99], v6 offset:3136
    v_mfma_f32_16x16x32_bf16 v[32:35], v[112:115], v[152:155], v[32:35]
    ds_read2_b32 v[64:65], v215 offset0:96 offset1:97
    v_mfma_f32_16x16x32_bf16 v[36:39], v[112:115], v[156:159], v[36:39]
    ds_read2_b32 v[66:67], v215 offset0:98 offset1:99
    v_mfma_f32_16x16x32_bf16 v[20:23], v[116:119], v[136:139], v[20:23]
    ds_read_b128 v[100:103], v6 offset:3648
    v_mfma_f32_16x16x32_bf16 v[24:27], v[116:119], v[140:143], v[24:27]
    ds_read2_b32 v[68:69], v215 offset0:224 offset1:225
    v_mfma_f32_16x16x32_bf16 v[28:31], v[116:119], v[144:147], v[28:31]
    ds_read2_b32 v[70:71], v215 offset0:226 offset1:227
    v_mfma_f32_16x16x32_bf16 v[32:35], v[116:119], v[148:151], v[32:35]
    v_mfma_f32_16x16x32_bf16 v[36:39], v[116:119], v[152:155], v[36:39]
    v_mfma_f32_16x16x32_bf16 v[24:27], v[120:123], v[136:139], v[24:27]
    v_mfma_f32_16x16x32_bf16 v[28:31], v[120:123], v[140:143], v[28:31]
    v_mfma_f32_16x16x32_bf16 v[32:35], v[120:123], v[144:147], v[32:35]
    v_mfma_f32_16x16x32_bf16 v[36:39], v[120:123], v[148:151], v[36:39]
    v_mfma_f32_16x16x32_bf16 v[28:31], v[124:127], v[136:139], v[28:31]
    v_mfma_f32_16x16x32_bf16 v[32:35], v[124:127], v[140:143], v[32:35]
    v_mfma_f32_16x16x32_bf16 v[36:39], v[124:127], v[144:147], v[36:39]
    v_mfma_f32_16x16x32_bf16 v[32:35], v[128:131], v[136:139], v[32:35]
    v_mfma_f32_16x16x32_bf16 v[36:39], v[128:131], v[140:143], v[36:39]
    v_mfma_f32_16x16x32_bf16 v[36:39], v[132:135], v[136:139], v[36:39]
    s_waitcnt lgkmcnt(0)
    v_mfma_f32_16x16x32_bf16 v[8:11], v[40:43], v[72:75], v[8:11]
    ds_read_b128 v[136:139], v6 offset:0
    v_mfma_f32_16x16x32_bf16 v[12:15], v[40:43], v[76:79], v[12:15]
    ds_read2_b32 v[104:105], v212 offset0:112 offset1:113
    v_mfma_f32_16x16x32_bf16 v[16:19], v[40:43], v[80:83], v[16:19]
    ds_read2_b32 v[106:107], v212 offset0:114 offset1:115
    v_mfma_f32_16x16x32_bf16 v[20:23], v[40:43], v[84:87], v[20:23]
    ds_read_b128 v[140:143], v6 offset:512
    v_mfma_f32_16x16x32_bf16 v[24:27], v[40:43], v[88:91], v[24:27]
    ds_read2_b32 v[108:109], v212 offset0:240 offset1:241
    v_mfma_f32_16x16x32_bf16 v[28:31], v[40:43], v[92:95], v[28:31]
    ds_read2_b32 v[110:111], v212 offset0:242 offset1:243
    v_mfma_f32_16x16x32_bf16 v[32:35], v[40:43], v[96:99], v[32:35]
    ds_read_b128 v[144:147], v6 offset:1024
    v_mfma_f32_16x16x32_bf16 v[36:39], v[40:43], v[100:103], v[36:39]
    ds_read2_b32 v[112:113], v213 offset0:112 offset1:113
    v_mfma_f32_16x16x32_bf16 v[12:15], v[44:47], v[72:75], v[12:15]
    ds_read2_b32 v[114:115], v213 offset0:114 offset1:115
    v_mfma_f32_16x16x32_bf16 v[16:19], v[44:47], v[76:79], v[16:19]
    ds_read_b128 v[148:151], v6 offset:1536
    v_mfma_f32_16x16x32_bf16 v[20:23], v[44:47], v[80:83], v[20:23]
    ds_read2_b32 v[116:117], v213 offset0:240 offset1:241
    v_mfma_f32_16x16x32_bf16 v[24:27], v[44:47], v[84:87], v[24:27]
    ds_read2_b32 v[118:119], v213 offset0:242 offset1:243
    v_mfma_f32_16x16x32_bf16 v[28:31], v[44:47], v[88:91], v[28:31]
    ds_read_b128 v[152:155], v6 offset:2048
    v_mfma_f32_16x16x32_bf16 v[32:35], v[44:47], v[92:95], v[32:35]
    ds_read2_b32 v[120:121], v214 offset0:112 offset1:113
    v_mfma_f32_16x16x32_bf16 v[36:39], v[44:47], v[96:99], v[36:39]
    ds_read2_b32 v[122:123], v214 offset0:114 offset1:115
    v_mfma_f32_16x16x32_bf16 v[16:19], v[48:51], v[72:75], v[16:19]
    ds_read_b128 v[156:159], v6 offset:2560
    v_mfma_f32_16x16x32_bf16 v[20:23], v[48:51], v[76:79], v[20:23]
    ds_read2_b32 v[124:125], v214 offset0:240 offset1:241
    v_mfma_f32_16x16x32_bf16 v[24:27], v[48:51], v[80:83], v[24:27]
    ds_read2_b32 v[126:127], v214 offset0:242 offset1:243
    v_mfma_f32_16x16x32_bf16 v[28:31], v[48:51], v[84:87], v[28:31]
    ds_read_b128 v[160:163], v6 offset:3072
    v_mfma_f32_16x16x32_bf16 v[32:35], v[48:51], v[88:91], v[32:35]
    ds_read2_b32 v[128:129], v215 offset0:112 offset1:113
    v_mfma_f32_16x16x32_bf16 v[36:39], v[48:51], v[92:95], v[36:39]
    ds_read2_b32 v[130:131], v215 offset0:114 offset1:115
    v_mfma_f32_16x16x32_bf16 v[20:23], v[52:55], v[72:75], v[20:23]
    ds_read_b128 v[164:167], v6 offset:3584
    v_mfma_f32_16x16x32_bf16 v[24:27], v[52:55], v[76:79], v[24:27]
    ds_read2_b32 v[132:133], v215 offset0:240 offset1:241
    v_mfma_f32_16x16x32_bf16 v[28:31], v[52:55], v[80:83], v[28:31]
    ds_read2_b32 v[134:135], v215 offset0:242 offset1:243
    v_mfma_f32_16x16x32_bf16 v[32:35], v[52:55], v[84:87], v[32:35]
    v_mfma_f32_16x16x32_bf16 v[36:39], v[52:55], v[88:91], v[36:39]
    v_mfma_f32_16x16x32_bf16 v[24:27], v[56:59], v[72:75], v[24:27]
    v_mfma_f32_16x16x32_bf16 v[28:31], v[56:59], v[76:79], v[28:31]
    v_mfma_f32_16x16x32_bf16 v[32:35], v[56:59], v[80:83], v[32:35]
    v_mfma_f32_16x16x32_bf16 v[36:39], v[56:59], v[84:87], v[36:39]
    v_mfma_f32_16x16x32_bf16 v[28:31], v[60:63], v[72:75], v[28:31]
    v_mfma_f32_16x16x32_bf16 v[32:35], v[60:63], v[76:79], v[32:35]
    v_mfma_f32_16x16x32_bf16 v[36:39], v[60:63], v[80:83], v[36:39]
    v_mfma_f32_16x16x32_bf16 v[32:35], v[64:67], v[72:75], v[32:35]
    v_mfma_f32_16x16x32_bf16 v[36:39], v[64:67], v[76:79], v[36:39]
    v_mfma_f32_16x16x32_bf16 v[36:39], v[68:71], v[72:75], v[36:39]
    s_waitcnt lgkmcnt(0)
    v_mfma_f32_16x16x32_bf16 v[8:11], v[104:107], v[136:139], v[8:11]
    v_mfma_f32_16x16x32_bf16 v[12:15], v[104:107], v[140:143], v[12:15]
    v_mfma_f32_16x16x32_bf16 v[16:19], v[104:107], v[144:147], v[16:19]
    v_mfma_f32_16x16x32_bf16 v[20:23], v[104:107], v[148:151], v[20:23]
    v_mfma_f32_16x16x32_bf16 v[24:27], v[104:107], v[152:155], v[24:27]
    v_mfma_f32_16x16x32_bf16 v[28:31], v[104:107], v[156:159], v[28:31]
    v_mfma_f32_16x16x32_bf16 v[32:35], v[104:107], v[160:163], v[32:35]
    v_mfma_f32_16x16x32_bf16 v[36:39], v[104:107], v[164:167], v[36:39]
    v_mfma_f32_16x16x32_bf16 v[12:15], v[108:111], v[136:139], v[12:15]
    v_mfma_f32_16x16x32_bf16 v[16:19], v[108:111], v[140:143], v[16:19]
    v_mfma_f32_16x16x32_bf16 v[20:23], v[108:111], v[144:147], v[20:23]
    v_mfma_f32_16x16x32_bf16 v[24:27], v[108:111], v[148:151], v[24:27]
    v_mfma_f32_16x16x32_bf16 v[28:31], v[108:111], v[152:155], v[28:31]
    v_mfma_f32_16x16x32_bf16 v[32:35], v[108:111], v[156:159], v[32:35]
    v_mfma_f32_16x16x32_bf16 v[36:39], v[108:111], v[160:163], v[36:39]
    v_mfma_f32_16x16x32_bf16 v[16:19], v[112:115], v[136:139], v[16:19]
    v_mfma_f32_16x16x32_bf16 v[20:23], v[112:115], v[140:143], v[20:23]
    v_mfma_f32_16x16x32_bf16 v[24:27], v[112:115], v[144:147], v[24:27]
    v_mfma_f32_16x16x32_bf16 v[28:31], v[112:115], v[148:151], v[28:31]
    v_mfma_f32_16x16x32_bf16 v[32:35], v[112:115], v[152:155], v[32:35]
    v_mfma_f32_16x16x32_bf16 v[36:39], v[112:115], v[156:159], v[36:39]
    v_mfma_f32_16x16x32_bf16 v[20:23], v[116:119], v[136:139], v[20:23]
    v_mfma_f32_16x16x32_bf16 v[24:27], v[116:119], v[140:143], v[24:27]
    v_mfma_f32_16x16x32_bf16 v[28:31], v[116:119], v[144:147], v[28:31]
    v_mfma_f32_16x16x32_bf16 v[32:35], v[116:119], v[148:151], v[32:35]
    v_mfma_f32_16x16x32_bf16 v[36:39], v[116:119], v[152:155], v[36:39]
    v_mfma_f32_16x16x32_bf16 v[24:27], v[120:123], v[136:139], v[24:27]
    v_mfma_f32_16x16x32_bf16 v[28:31], v[120:123], v[140:143], v[28:31]
    v_mfma_f32_16x16x32_bf16 v[32:35], v[120:123], v[144:147], v[32:35]
    v_mfma_f32_16x16x32_bf16 v[36:39], v[120:123], v[148:151], v[36:39]
    v_mfma_f32_16x16x32_bf16 v[28:31], v[124:127], v[136:139], v[28:31]
    v_mfma_f32_16x16x32_bf16 v[32:35], v[124:127], v[140:143], v[32:35]
    v_mfma_f32_16x16x32_bf16 v[36:39], v[124:127], v[144:147], v[36:39]
    v_mfma_f32_16x16x32_bf16 v[32:35], v[128:131], v[136:139], v[32:35]
    v_mfma_f32_16x16x32_bf16 v[36:39], v[128:131], v[140:143], v[36:39]
    v_mfma_f32_16x16x32_bf16 v[36:39], v[132:135], v[136:139], v[36:39]
    v_lshrrev_b32 v201, 1, v3
    v_lshlrev_b32 v201, 4, v201
    v_and_b32 v203, 1, v3
    v_xor_b32 v203, 1, v203
    v_lshlrev_b32 v203, 3, v203
    v_add_u32 v201, v201, v203
    v_lshlrev_b32 v203, 5, v2
    v_add_u32 v201, v201, v203
    v_add_u32 v201, s30, v201
    v_lshlrev_b32 v202, 3, v3
    v_add_u32 v202, v202, v203
    s_add_u32 s37, s36, 10878976
    ds_read_b64 v[40:41], v201 offset:8832
    ds_read_b64 v[42:43], v201 offset:9344
    ds_read_b64 v[44:45], v201 offset:9856
    ds_read_b64 v[46:47], v201 offset:10368
    ds_read_b64 v[48:49], v201 offset:10880
    ds_read_b64 v[50:51], v201 offset:11392
    ds_read_b64 v[52:53], v201 offset:11904
    ds_read_b64 v[54:55], v201 offset:12416
    s_waitcnt lgkmcnt(0)
    v_cvt_pk_bf16_f32 v60, v8, v9
    v_cvt_pk_bf16_f32 v61, v10, v11
    v_lshlrev_b32 v8, 16, v60
    v_and_b32 v9, 0xffff0000, v60
    v_lshlrev_b32 v10, 16, v61
    v_and_b32 v11, 0xffff0000, v61
    v_and_b32 v62, 0xffff0000, v41
    v_lshlrev_b32 v63, 16, v41
    v_and_b32 v64, 0xffff0000, v40
    v_lshlrev_b32 v65, 16, v40
    v_fma_f32 v8, v62, v7, v8
    v_fma_f32 v9, v63, v7, v9
    v_fma_f32 v10, v64, v7, v10
    v_fma_f32 v11, v65, v7, v11
    v_cvt_pk_bf16_f32 v80, v8, v9
    v_cvt_pk_bf16_f32 v81, v10, v11
    buffer_store_dwordx2 v[80:81], v202, s[16:19], s37 offen offset:0 sc1
    v_cvt_pk_bf16_f32 v68, v12, v13
    v_cvt_pk_bf16_f32 v69, v14, v15
    v_lshlrev_b32 v12, 16, v68
    v_and_b32 v13, 0xffff0000, v68
    v_lshlrev_b32 v14, 16, v69
    v_and_b32 v15, 0xffff0000, v69
    v_and_b32 v70, 0xffff0000, v43
    v_lshlrev_b32 v71, 16, v43
    v_and_b32 v72, 0xffff0000, v42
    v_lshlrev_b32 v73, 16, v42
    v_fma_f32 v12, v70, v7, v12
    v_fma_f32 v13, v71, v7, v13
    v_fma_f32 v14, v72, v7, v14
    v_fma_f32 v15, v73, v7, v15
    v_cvt_pk_bf16_f32 v82, v12, v13
    v_cvt_pk_bf16_f32 v83, v14, v15
    buffer_store_dwordx2 v[82:83], v202, s[16:19], s37 offen offset:512 sc1
    v_cvt_pk_bf16_f32 v60, v16, v17
    v_cvt_pk_bf16_f32 v61, v18, v19
    v_lshlrev_b32 v16, 16, v60
    v_and_b32 v17, 0xffff0000, v60
    v_lshlrev_b32 v18, 16, v61
    v_and_b32 v19, 0xffff0000, v61
    v_and_b32 v62, 0xffff0000, v45
    v_lshlrev_b32 v63, 16, v45
    v_and_b32 v64, 0xffff0000, v44
    v_lshlrev_b32 v65, 16, v44
    v_fma_f32 v16, v62, v7, v16
    v_fma_f32 v17, v63, v7, v17
    v_fma_f32 v18, v64, v7, v18
    v_fma_f32 v19, v65, v7, v19
    v_cvt_pk_bf16_f32 v84, v16, v17
    v_cvt_pk_bf16_f32 v85, v18, v19
    buffer_store_dwordx2 v[84:85], v202, s[16:19], s37 offen offset:1024 sc1
    v_cvt_pk_bf16_f32 v68, v20, v21
    v_cvt_pk_bf16_f32 v69, v22, v23
    v_lshlrev_b32 v20, 16, v68
    v_and_b32 v21, 0xffff0000, v68
    v_lshlrev_b32 v22, 16, v69
    v_and_b32 v23, 0xffff0000, v69
    v_and_b32 v70, 0xffff0000, v47
    v_lshlrev_b32 v71, 16, v47
    v_and_b32 v72, 0xffff0000, v46
    v_lshlrev_b32 v73, 16, v46
    v_fma_f32 v20, v70, v7, v20
    v_fma_f32 v21, v71, v7, v21
    v_fma_f32 v22, v72, v7, v22
    v_fma_f32 v23, v73, v7, v23
    v_cvt_pk_bf16_f32 v86, v20, v21
    v_cvt_pk_bf16_f32 v87, v22, v23
    buffer_store_dwordx2 v[86:87], v202, s[16:19], s37 offen offset:1536 sc1
    v_cvt_pk_bf16_f32 v60, v24, v25
    v_cvt_pk_bf16_f32 v61, v26, v27
    v_lshlrev_b32 v24, 16, v60
    v_and_b32 v25, 0xffff0000, v60
    v_lshlrev_b32 v26, 16, v61
    v_and_b32 v27, 0xffff0000, v61
    v_and_b32 v62, 0xffff0000, v49
    v_lshlrev_b32 v63, 16, v49
    v_and_b32 v64, 0xffff0000, v48
    v_lshlrev_b32 v65, 16, v48
    v_fma_f32 v24, v62, v7, v24
    v_fma_f32 v25, v63, v7, v25
    v_fma_f32 v26, v64, v7, v26
    v_fma_f32 v27, v65, v7, v27
    v_cvt_pk_bf16_f32 v88, v24, v25
    v_cvt_pk_bf16_f32 v89, v26, v27
    buffer_store_dwordx2 v[88:89], v202, s[16:19], s37 offen offset:2048 sc1
    v_cvt_pk_bf16_f32 v68, v28, v29
    v_cvt_pk_bf16_f32 v69, v30, v31
    v_lshlrev_b32 v28, 16, v68
    v_and_b32 v29, 0xffff0000, v68
    v_lshlrev_b32 v30, 16, v69
    v_and_b32 v31, 0xffff0000, v69
    v_and_b32 v70, 0xffff0000, v51
    v_lshlrev_b32 v71, 16, v51
    v_and_b32 v72, 0xffff0000, v50
    v_lshlrev_b32 v73, 16, v50
    v_fma_f32 v28, v70, v7, v28
    v_fma_f32 v29, v71, v7, v29
    v_fma_f32 v30, v72, v7, v30
    v_fma_f32 v31, v73, v7, v31
    v_cvt_pk_bf16_f32 v90, v28, v29
    v_cvt_pk_bf16_f32 v91, v30, v31
    buffer_store_dwordx2 v[90:91], v202, s[16:19], s37 offen offset:2560 sc1
    v_cvt_pk_bf16_f32 v60, v32, v33
    v_cvt_pk_bf16_f32 v61, v34, v35
    v_lshlrev_b32 v32, 16, v60
    v_and_b32 v33, 0xffff0000, v60
    v_lshlrev_b32 v34, 16, v61
    v_and_b32 v35, 0xffff0000, v61
    v_and_b32 v62, 0xffff0000, v53
    v_lshlrev_b32 v63, 16, v53
    v_and_b32 v64, 0xffff0000, v52
    v_lshlrev_b32 v65, 16, v52
    v_fma_f32 v32, v62, v7, v32
    v_fma_f32 v33, v63, v7, v33
    v_fma_f32 v34, v64, v7, v34
    v_fma_f32 v35, v65, v7, v35
    v_cvt_pk_bf16_f32 v92, v32, v33
    v_cvt_pk_bf16_f32 v93, v34, v35
    buffer_store_dwordx2 v[92:93], v202, s[16:19], s37 offen offset:3072 sc1
    v_cvt_pk_bf16_f32 v68, v36, v37
    v_cvt_pk_bf16_f32 v69, v38, v39
    v_lshlrev_b32 v36, 16, v68
    v_and_b32 v37, 0xffff0000, v68
    v_lshlrev_b32 v38, 16, v69
    v_and_b32 v39, 0xffff0000, v69
    v_and_b32 v70, 0xffff0000, v55
    v_lshlrev_b32 v71, 16, v55
    v_and_b32 v72, 0xffff0000, v54
    v_lshlrev_b32 v73, 16, v54
    v_fma_f32 v36, v70, v7, v36
    v_fma_f32 v37, v71, v7, v37
    v_fma_f32 v38, v72, v7, v38
    v_fma_f32 v39, v73, v7, v39
    v_cvt_pk_bf16_f32 v94, v36, v37
    v_cvt_pk_bf16_f32 v95, v38, v39
    buffer_store_dwordx2 v[94:95], v202, s[16:19], s37 offen offset:3584 sc1
    s_waitcnt vmcnt(0)
    v_mov_b32 v9, 115100
    v_mov_b32 v10, 1
    v_mov_b32 v12, 0
    s_mov_b64 exec, 1
    ds_add_rtn_u32 v11, v9, v10
    s_cmp_ge_u32 s26, 16
    s_cselect_b32 s39, 1, 2
    s_waitcnt lgkmcnt(0)
    v_readfirstlane_b32 s38, v11
    s_cmp_lg_u32 s38, s39
    s_cbranch_scc1 A_nozflag
    s_lshl_b32 s38, s2, 7
    s_add_u32 s38, s38, 13516808
    buffer_store_dword v10, v12, s[16:19], s38 offen sc1
A_nozflag:
    s_mov_b64 exec, -1
    s_endpgm
A_cend:
    s_cmp_eq_u32 s24, 7
    s_cbranch_scc1 B_aux
    s_endpgm
B_aux:
    s_setprio 3
    s_load_dwordx2 s[34:35], s[0:1], 104
    s_and_b32 s27, s2, 7
    s_lshr_b32 s28, s2, 3
    s_and_b32 s25, s27, 1
    s_lshl_b32 s25, s25, 2
    s_and_b32 s29, s28, 3
    s_add_u32 s25, s25, s29
    s_lshr_b32 s26, s27, 1
    s_lshl_b32 s26, s26, 3
    s_lshr_b32 s29, s28, 2
    s_add_u32 s26, s26, s29
    s_waitcnt lgkmcnt(0)
    s_mov_b32 s16, s34
    s_mov_b32 s17, s35
    s_mov_b32 s18, 13680640
    s_mov_b32 s19, 0x00020000
    v_lshrrev_b32 v6, 3, v1
    v_lshlrev_b32 v6, 12, v6
    v_and_b32 v7, 7, v1
    v_lshlrev_b32 v7, 4, v7
    v_add_u32 v6, v6, v7
    s_mul_i32 s30, s25, 327680
    s_lshl_b32 s31, s26, 7
    s_add_u32 s30, s30, s31
    s_add_u32 s30, s30, 10878976
    v_mov_b32 v249, 115092
B_ago:
    ds_read_b32 v244, v249
    s_waitcnt lgkmcnt(0)
    v_cmp_gt_u32 vcc, 1, v244
    s_nop 1
    s_cbranch_vccz B_ago_ok
    s_sleep 8
    s_branch B_ago
B_ago_ok:
    s_mul_i32 s29, s25, 12
    s_add_u32 s29, s29, 160
    v_min_u32 v8, 11, v1
    v_add_u32 v8, s29, v8
    v_lshlrev_b32 v8, 7, v8
    v_add_u32 v8, 13516812, v8
    s_lshr_b32 s28, s26, 1
    s_lshr_b32 s29, s28, 2
    s_lshl_b32 s29, s29, 1
    s_and_b32 s28, s28, 3
    v_bfe_u32 v9, v1, 3, 1
    v_add_u32 v9, s29, v9
    v_and_b32 v10, 7, v1
    v_lshlrev_b32 v10, 2, v10
    v_add_u32 v10, s28, v10
    v_lshlrev_b32 v10, 3, v10
    v_add_u32 v9, v9, v10
    v_lshlrev_b32 v9, 7, v9
    v_add_u32 v9, 13516804, v9
    v_and_b32 v10, 31, v1
    v_lshlrev_b32 v10, 3, v10
    v_add_u32 v10, s25, v10
    v_lshlrev_b32 v10, 7, v10
    v_add_u32 v10, 13516808, v10
    s_mov_b32 s40, 0
B_pw:
    s_add_u32 s40, s40, 1
    s_cmp_ge_u32 s40, 0x40000
    s_cbranch_scc1 B_pw_ok
    buffer_load_dword v245, v8, s[16:19], 0 offen sc1
    s_waitcnt vmcnt(0)
    v_cmp_ne_u32 vcc, 1, v245
    s_nop 1
    s_cbranch_vccz B_pw_ok
    s_sleep 8
    s_branch B_pw
B_pw_ok:
    v_mov_b32 v248, 115112
    v_mov_b32 v250, 1
    s_mov_b64 exec, 1
    ds_write_b32 v248, v250
    s_mov_b64 exec, -1
    v_mov_b32 v249, 115072
B_ring:
    ds_read_b128 v[244:247], v249
    s_waitcnt lgkmcnt(0)
    v_min3_u32 v244, v244, v245, v246
    v_min_u32 v244, v244, v247
    v_cmp_gt_u32 vcc, 12, v244
    s_nop 1
    s_cbranch_vccz B_ring_ok
    s_sleep 2
    s_branch B_ring
B_ring_ok:
    s_mul_i32 s28, s25, 245760
    s_add_u32 s28, s28, 6306816
    v_lshlrev_b32 v11, 4, v1
    s_add_u32 s29, s28, 0
    s_mov_b32 m0, 0
    s_mov_b32 s38, 0
B_wl0:
    buffer_load_dwordx4 v11, s[16:19], s29 offen lds
    s_add_u32 s29, s29, 1024
    s_add_u32 m0, m0, 1024
    s_add_u32 s38, s38, 1
    s_waitcnt vmcnt(40)
    s_cmp_lt_u32 s38, 25
    s_cbranch_scc1 B_wl0
    s_add_u32 s29, s28, 61440
    s_mov_b32 m0, 25600
    s_mov_b32 s38, 0
B_wl1:
    buffer_load_dwordx4 v11, s[16:19], s29 offen lds
    s_add_u32 s29, s29, 1024
    s_add_u32 m0, m0, 1024
    s_add_u32 s38, s38, 1
    s_waitcnt vmcnt(40)
    s_cmp_lt_u32 s38, 25
    s_cbranch_scc1 B_wl1
    s_add_u32 s29, s28, 122880
    s_mov_b32 m0, 51200
    s_mov_b32 s38, 0
B_wl2:
    buffer_load_dwordx4 v11, s[16:19], s29 offen lds
    s_add_u32 s29, s29, 1024
    s_add_u32 m0, m0, 1024
    s_add_u32 s38, s38, 1
    s_waitcnt vmcnt(40)
    s_cmp_lt_u32 s38, 25
    s_cbranch_scc1 B_wl2
    s_add_u32 s29, s28, 184320
    s_mov_b32 m0, 76800
    s_mov_b32 s38, 0
B_wl3:
    buffer_load_dwordx4 v11, s[16:19], s29 offen lds
    s_add_u32 s29, s29, 1024
    s_add_u32 m0, m0, 1024
    s_add_u32 s38, s38, 1
    s_waitcnt vmcnt(40)
    s_cmp_lt_u32 s38, 25
    s_cbranch_scc1 B_wl3
    s_waitcnt vmcnt(0)
    v_mov_b32 v249, 115096
B_own:
    ds_read_b32 v244, v249
    s_waitcnt lgkmcnt(0)
    v_cmp_gt_u32 vcc, 4, v244
    s_nop 1
    s_cbranch_vccz B_own_ok
    s_sleep 2
    s_branch B_own
B_own_ok:
    s_mov_b32 s40, 0
B_ph:
    s_add_u32 s40, s40, 1
    s_cmp_ge_u32 s40, 0x40000
    s_cbranch_scc1 B_ph_ok
    buffer_load_dword v245, v9, s[16:19], 0 offen sc1
    s_waitcnt vmcnt(0)
    v_cmp_ne_u32 vcc, 1, v245
    s_nop 1
    s_cbranch_vccz B_ph_ok
    s_sleep 1
    s_branch B_ph
B_ph_ok:
    v_mov_b32 v248, 115104
    v_mov_b32 v250, 1
    s_mov_b64 exec, 1
    ds_write_b32 v248, v250
    s_mov_b64 exec, -1
    s_mov_b32 s40, 0
B_pz:
    s_add_u32 s40, s40, 1
    s_cmp_ge_u32 s40, 0x40000
    s_cbranch_scc1 B_pz_ok
    buffer_load_dword v245, v10, s[16:19], 0 offen sc1
    s_waitcnt vmcnt(0)
    v_cmp_ne_u32 vcc, 1, v245
    s_nop 1
    s_cbranch_vccz B_pz_ok
    s_sleep 1
    s_branch B_pz
B_pz_ok:
    s_mov_b32 m0, 102400
    s_nop 0
    buffer_load_dwordx4 v6, s[16:19], s30 offen lds
    s_add_u32 s30, s30, 32768
    s_mov_b32 m0, 103424
    s_nop 0
    buffer_load_dwordx4 v6, s[16:19], s30 offen lds
    s_add_u32 s30, s30, 32768
    s_mov_b32 m0, 104448
    s_nop 0
    buffer_load_dwordx4 v6, s[16:19], s30 offen lds
    s_add_u32 s30, s30, 32768
    s_mov_b32 m0, 105472
    s_nop 0
    buffer_load_dwordx4 v6, s[16:19], s30 offen lds
    s_add_u32 s30, s30, 32768
    s_mov_b32 m0, 106496
    s_nop 0
    buffer_load_dwordx4 v6, s[16:19], s30 offen lds
    s_add_u32 s30, s30, 32768
    s_mov_b32 m0, 107520
    s_nop 0
    buffer_load_dwordx4 v6, s[16:19], s30 offen lds
    s_add_u32 s30, s30, 32768
    s_mov_b32 m0, 108544
    s_nop 0
    buffer_load_dwordx4 v6, s[16:19], s30 offen lds
    s_add_u32 s30, s30, 32768
    s_mov_b32 m0, 109568
    s_nop 0
    buffer_load_dwordx4 v6, s[16:19], s30 offen lds
    s_add_u32 s30, s30, 32768
    s_mov_b32 m0, 110592
    s_nop 0
    buffer_load_dwordx4 v6, s[16:19], s30 offen lds
    s_add_u32 s30, s30, 32768
    s_mov_b32 m0, 111616
    s_nop 0
    buffer_load_dwordx4 v6, s[16:19], s30 offen lds
    s_add_u32 s30, s30, 32768
    s_waitcnt vmcnt(0)
    v_mov_b32 v248, 115108
    v_mov_b32 v250, 14
    s_mov_b64 exec, 1
    ds_write_b32 v248, v250
    s_mov_b64 exec, -1
    s_endpgm
A_exit:
    s_endpgm
.section .rodata,"a"
.p2align 6
.amdhsa_kernel parallel_sum__ssm_conv_h3__dense_activation_gelu__prompt_kernel
  .amdhsa_next_free_vgpr 256
  .amdhsa_next_free_sgpr 102
  .amdhsa_accum_offset 256
  .amdhsa_group_segment_fixed_size 0
  .amdhsa_kernarg_size 112
  .amdhsa_user_sgpr_count 2
  .amdhsa_user_sgpr_kernarg_segment_ptr 1
  .amdhsa_system_sgpr_workgroup_id_x 1
.end_amdhsa_kernel
```
